```python
import torch

def _softmax(x, axis=-1):
    return torch.softmax(x, dim=axis)

def _gelu(x):
    return torch.nn.functional.gelu(x, approximate='tanh')

def _silu(x):
    return torch.nn.functional.silu(x)

def _sigmoid(x):
    return torch.sigmoid(x)

def _layernorm(x, axis=-1, eps=1e-05):
    m = x.mean(dim=axis, keepdim=True)
    v = x.var(dim=axis, keepdim=True, unbiased=False)
    return (x - m) / torch.sqrt(v + eps)

def _scatter_add(tgt, idx, src, axis=0):
    return tgt.clone().index_add_(axis, idx, src)

def _segment_sum(src, seg, n):
    out = torch.zeros((n,) + src.shape[1:], dtype=src.dtype)
    return out.index_add_(0, seg, src)

def _pad(x, pw):
    flat = tuple((v for pair in reversed(pw) for v in pair))
    return torch.nn.functional.pad(x, flat)
kernel_name = 'parallel_sum__grouped_kv_mqa__mixer_gmlp__prompt'

def setup_inputs():

    _w = lambda a: (lambda t: t.to(torch.bfloat16) if t.is_floating_point() else t)(torch.as_tensor(a))

    def _A_setup():
        B, S, D, H = (1, 2048, 512, 32)
        Dh = D // H
        return {'x': _w((lambda *s: torch.randn(*s, dtype=torch.bfloat16) * 0.05)(B, S, D)), 'wq': _w((lambda *s: torch.randn(*s, dtype=torch.bfloat16) * 0.1)(D, H * Dh)), 'wk': _w((lambda *s: torch.randn(*s, dtype=torch.bfloat16) * 0.1)(D, Dh)), 'wv': _w((lambda *s: torch.randn(*s, dtype=torch.bfloat16) * 0.05)(D, Dh)), 'wo': _w((lambda *s: torch.randn(*s, dtype=torch.bfloat16) * 0.05)(H * Dh, D))}
    _A_in = _A_setup()

    def _B_setup():
        B, S, D, F = (1, 2048, 512, 1792)
        Fh = F // 2
        return {'x': _w((lambda *s: torch.randn(*s, dtype=torch.bfloat16) * 0.05)(B, S, D)), 'w_in': _w((lambda *s: torch.randn(*s, dtype=torch.bfloat16) * 0.2)(D, 2 * Fh)), 'w_sp': _w(0.01 * (lambda *s: torch.randn(*s, dtype=torch.bfloat16) * 0.2)(S, S)), 'b_sp': _w(1.0 + 0.01 * (lambda *s: torch.randn(*s, dtype=torch.bfloat16) * 0.05)(S)), 'w_out': _w((lambda *s: torch.randn(*s, dtype=torch.bfloat16) * 0.05)(Fh, D))}
    _B_in = _B_setup()
    return {'A_x': _A_in['x'], 'A_wq': _A_in['wq'], 'A_wk': _A_in['wk'], 'A_wv': _A_in['wv'], 'A_wo': _A_in['wo'], 'B_x': _B_in['x'], 'B_w_in': _B_in['w_in'], 'B_w_sp': _B_in['w_sp'], 'B_b_sp': _B_in['b_sp'], 'B_w_out': _B_in['w_out']}

def reference(A_x, A_wq, A_wk, A_wv, A_wo, B_x, B_w_in, B_w_sp, B_b_sp, B_w_out):

    def _A_ref(x, wq, wk, wv, wo):
        B, S, D = x.shape
        H = 32
        Dh = D // H
        q = (lambda x, *d: x.permute(*d))((x @ wq).reshape(B, S, H, Dh), 0, 2, 1, 3)
        k = x @ wk
        v = x @ wv
        scores = torch.einsum('bhqd,bkd->bhqk', q, k) * Dh ** (-0.5)
        p = _softmax(scores, axis=-1)
        o = torch.einsum('bhqk,bkd->bhqd', p, v)
        return (lambda x, *d: x.permute(*d))(o, 0, 2, 1, 3).reshape(B, S, H * Dh) @ wo

    def _B_ref(x, w_in, w_sp, b_sp, w_out):
        B, S, D = x.shape
        F = w_in.shape[-1]
        Fh = F // 2
        z = _gelu(torch.einsum('bsd,df->bsf', x, w_in))
        z1 = z[..., :Fh].clone()
        z2 = _layernorm(z[..., Fh:], axis=-1)
        g = torch.einsum('ts,bsf->btf', w_sp, z2) + b_sp[None, :, None]
        return torch.einsum('bsf,fd->bsd', z1 * g, w_out)
    x = A_x
    xn = _layernorm(x, axis=-1)
    return x + _A_ref(xn, A_wq, A_wk, A_wv, A_wo) + _B_ref(xn, B_w_in, B_w_sp, B_b_sp, B_w_out)
```

```asm
; @launch kernel=p1_kernel grid=(256,1,1) block=(512,1,1) lds=153600
; @launch kernel=p23_kernel grid=(256,1,1) block=(512,1,1) lds=163840
.amdgcn_target "amdgcn-amd-amdhsa--gfx950"
.text
.globl p1_kernel
.p2align 8
.type p1_kernel,@function
p1_kernel:
    s_cmp_ge_u32 s2, 256
    s_cbranch_scc1 L_p1_kernel_end
    s_getpc_b64 s[4:5]
L_p1_kernel_pc0:
    v_lshlrev_b32 v2, 7, v0
    v_min_u32 v2, p23_kernel_codeend-L_p1_kernel_pc0, v2
    v_cmp_gt_u32 vcc, 384, v0
    s_and_saveexec_b64 s[6:7], vcc
    s_cbranch_execz L_p1_kernel_st0
    global_load_dword v143, v2, s[4:5]
L_p1_kernel_st0:
    s_mov_b64 exec, s[6:7]
    s_load_dwordx4 s[4:7], s[0:1], 0
    s_load_dwordx4 s[8:11], s[0:1], 16
    s_load_dwordx2 s[12:13], s[0:1], 48
    s_load_dwordx2 s[14:15], s[0:1], 96
    v_and_b32 v1, 63, v0
    v_lshrrev_b32 v14, 6, v0
    s_nop 0
    v_readfirstlane_b32 s26, v14
    s_and_b32 s29, s2, 7
    s_lshr_b32 s30, s2, 3
    s_lshr_b32 s24, s29, 1
    s_lshl_b32 s24, s24, 2
    s_lshr_b32 s31, s30, 3
    s_add_u32 s24, s24, s31
    s_and_b32 s25, s29, 1
    s_lshl_b32 s25, s25, 3
    s_and_b32 s31, s30, 7
    s_add_u32 s25, s25, s31
    s_and_b32 s27, s26, 3
    s_lshr_b32 s28, s26, 2
    s_lshl_b32 s46, s24, 2
    s_add_u32 s46, s46, s27
    s_lshl_b32 s29, s24, 7
    s_lshl_b32 s30, s26, 4
    s_add_u32 s29, s29, s30
    s_lshl_b32 s29, s29, 10
    v_lshrrev_b32 v14, 4, v1
    v_xor_b32 v14, v14, v1
    v_and_b32 v14, 7, v14
    v_lshlrev_b32 v14, 4, v14
    v_lshrrev_b32 v15, 3, v1
    v_lshlrev_b32 v15, 10, v15
    v_add_u32 v14, v14, v15
    v_add_u32 v2, s29, v14
    v_lshrrev_b32 v14, 4, v1
    v_add_u32 v14, 4, v14
    v_xor_b32 v14, v14, v1
    v_and_b32 v14, 7, v14
    v_lshlrev_b32 v14, 4, v14
    v_lshrrev_b32 v15, 3, v1
    v_lshlrev_b32 v15, 10, v15
    v_add_u32 v14, v14, v15
    v_add_u32 v3, s29, v14
    v_add_u32 v3, 0x2000, v3
    s_waitcnt lgkmcnt(0)
    s_mov_b32 s16, s4
    s_mov_b32 s17, s5
    s_mov_b32 s18, 2097152
    s_mov_b32 s19, 0x00020000
    s_mov_b32 s20, s14
    s_mov_b32 s21, s15
    s_mov_b32 s22, 19398656
    s_mov_b32 s23, 0x00020000
    v_lshrrev_b32 v112, 3, v1
    s_lshl_b32 s29, s27, 4
    v_add_u32 v112, s29, v112
    v_bfe_u32 v113, v1, 4, 1
    v_lshlrev_b32 v113, 2, v113
    v_xor_b32 v113, v113, v1
    v_and_b32 v113, 7, v113
    v_lshlrev_b32 v113, 4, v113
    s_cmp_eq_u32 s28, 0
    s_cbranch_scc0 L_p1_kernel_addrY
    s_cmp_lt_u32 s25, 14
    s_cselect_b32 s29, s25, 0
    s_lshl_b32 s29, s29, 7
    s_add_u32 s48, s12, s29
    s_addc_u32 s49, s13, 0
    s_mov_b32 s50, 3584
    v_mul_lo_u32 v12, v112, s50
    v_add_u32 v12, v12, v113
    v_mov_b32 v55, s49
    v_add_co_u32 v54, vcc, s48, v12
    v_addc_co_u32 v55, vcc, 0, v55, vcc
    v_add_co_u32 v56, vcc, 28672, v54
    v_addc_co_u32 v57, vcc, 0, v55, vcc
    s_mov_b32 s41, 229376
    s_mov_b32 s42, 229376
    v_lshrrev_b32 v14, 2, v1
    s_lshl_b32 s29, s27, 4
    v_add_u32 v14, s29, v14
    v_and_b32 v15, 3, v1
    v_lshlrev_b32 v15, 4, v15
    s_lshl_b32 s29, s25, 6
    s_add_u32 s48, s6, s29
    s_addc_u32 s49, s7, 0
    v_lshlrev_b32 v12, 10, v14
    v_add_u32 v12, v12, v15
    v_mov_b32 v59, s49
    v_add_co_u32 v58, vcc, s48, v12
    v_addc_co_u32 v59, vcc, 0, v59, vcc
    s_mov_b32 s43, 65536
    s_cmp_eq_u32 s25, 14
    s_cbranch_scc0 L_p1_kernel_addrDone
    v_lshlrev_b32 v12, 5, v112
    v_and_b32 v14, 16, v113
    v_add_u32 v12, v12, v14
    v_and_b32 v14, 0x60, v113
    v_cmp_eq_u32 vcc, 32, v14
    v_mov_b32 v13, s8
    v_mov_b32 v55, s9
    v_mov_b32 v54, s10
    v_mov_b32 v15, s11
    v_cndmask_b32 v13, v13, v54, vcc
    v_cndmask_b32 v55, v55, v15, vcc
    v_add_co_u32 v54, vcc, v13, v12
    v_addc_co_u32 v55, vcc, 0, v55, vcc
    v_add_co_u32 v56, vcc, 256, v54
    v_addc_co_u32 v57, vcc, 0, v55, vcc
    s_mov_b32 s41, 2048
    s_mov_b32 s42, 2048
    s_branch L_p1_kernel_addrDone
L_p1_kernel_addrY:
    s_cmp_lt_u32 s25, 14
    s_cselect_b32 s29, s25, 0
    s_lshl_b32 s29, s29, 7
    s_add_u32 s29, s29, 1792
    s_add_u32 s48, s12, s29
    s_addc_u32 s49, s13, 0
    s_mov_b32 s50, 3584
    v_mul_lo_u32 v12, v112, s50
    v_add_u32 v12, v12, v113
    v_mov_b32 v55, s49
    v_add_co_u32 v54, vcc, s48, v12
    v_addc_co_u32 v55, vcc, 0, v55, vcc
    v_add_co_u32 v56, vcc, 28672, v54
    v_addc_co_u32 v57, vcc, 0, v55, vcc
    s_mov_b32 s41, 229376
    s_mov_b32 s42, 229376
    v_mov_b32 v58, v56
    v_mov_b32 v59, v57
    s_mov_b32 s43, 0
L_p1_kernel_addrDone:
    s_cmp_eq_u32 s28, 0
    s_cbranch_scc0 L_p1_kernel_Y
    s_mov_b32 s39, 0
    s_mov_b32 s29, 0
    s_lshl_b32 s40, s26, 11
    s_add_u32 s40, s40, s29
    s_add_u32 m0, s40, 0
    s_nop 0
    buffer_load_dwordx4 v2, s[16:19], s39 offen lds
    s_add_u32 m0, s40, 1024
    s_nop 0
    buffer_load_dwordx4 v3, s[16:19], s39 offen lds
    s_add_u32 s39, s39, 128
    s_lshl_b32 s40, s27, 11
    s_add_u32 s40, s40, s29
    s_add_u32 m0, s40, 16384
    s_nop 0
    global_load_lds_dwordx4 v[54:55], off
    v_add_co_u32 v54, vcc, s41, v54
    v_addc_co_u32 v55, vcc, 0, v55, vcc
    s_add_u32 m0, s40, 17408
    s_nop 0
    global_load_lds_dwordx4 v[56:57], off
    v_add_co_u32 v56, vcc, s42, v56
    v_addc_co_u32 v57, vcc, 0, v57, vcc
    s_lshl_b32 s40, s27, 10
    s_add_u32 s40, s40, s29
    s_add_u32 m0, s40, 24576
    s_nop 0
    global_load_lds_dwordx4 v[58:59], off
    v_add_co_u32 v58, vcc, s43, v58
    v_addc_co_u32 v59, vcc, 0, v59, vcc
    s_mov_b32 s29, 36864
    s_lshl_b32 s40, s26, 11
    s_add_u32 s40, s40, s29
    s_add_u32 m0, s40, 0
    s_nop 0
    buffer_load_dwordx4 v2, s[16:19], s39 offen lds
    s_add_u32 m0, s40, 1024
    s_nop 0
    buffer_load_dwordx4 v3, s[16:19], s39 offen lds
    s_add_u32 s39, s39, 128
    s_lshl_b32 s40, s27, 11
    s_add_u32 s40, s40, s29
    s_add_u32 m0, s40, 16384
    s_nop 0
    global_load_lds_dwordx4 v[54:55], off
    v_add_co_u32 v54, vcc, s41, v54
    v_addc_co_u32 v55, vcc, 0, v55, vcc
    s_add_u32 m0, s40, 17408
    s_nop 0
    global_load_lds_dwordx4 v[56:57], off
    v_add_co_u32 v56, vcc, s42, v56
    v_addc_co_u32 v57, vcc, 0, v57, vcc
    s_lshl_b32 s40, s27, 10
    s_add_u32 s40, s40, s29
    s_add_u32 m0, s40, 24576
    s_nop 0
    global_load_lds_dwordx4 v[58:59], off
    v_add_co_u32 v58, vcc, s43, v58
    v_addc_co_u32 v59, vcc, 0, v59, vcc
    s_mov_b32 s29, 73728
    s_lshl_b32 s40, s26, 11
    s_add_u32 s40, s40, s29
    s_add_u32 m0, s40, 0
    s_nop 0
    buffer_load_dwordx4 v2, s[16:19], s39 offen lds
    s_add_u32 m0, s40, 1024
    s_nop 0
    buffer_load_dwordx4 v3, s[16:19], s39 offen lds
    s_add_u32 s39, s39, 128
    s_lshl_b32 s40, s27, 11
    s_add_u32 s40, s40, s29
    s_add_u32 m0, s40, 16384
    s_nop 0
    global_load_lds_dwordx4 v[54:55], off
    v_add_co_u32 v54, vcc, s41, v54
    v_addc_co_u32 v55, vcc, 0, v55, vcc
    s_add_u32 m0, s40, 17408
    s_nop 0
    global_load_lds_dwordx4 v[56:57], off
    v_add_co_u32 v56, vcc, s42, v56
    v_addc_co_u32 v57, vcc, 0, v57, vcc
    s_lshl_b32 s40, s27, 10
    s_add_u32 s40, s40, s29
    s_add_u32 m0, s40, 24576
    s_nop 0
    global_load_lds_dwordx4 v[58:59], off
    v_add_co_u32 v58, vcc, s43, v58
    v_addc_co_u32 v59, vcc, 0, v59, vcc
    v_and_b32 v14, 31, v1
    v_lshrrev_b32 v15, 1, v14
    v_and_b32 v15, 7, v15
    v_lshrrev_b32 v12, 5, v1
    v_xor_b32 v15, v15, v12
    v_lshlrev_b32 v15, 4, v15
    v_lshlrev_b32 v14, 7, v14
    v_add_u32 v14, v14, v15
    s_lshl_b32 s29, s27, 12
    v_add_u32 v14, s29, v14
    v_lshrrev_b32 v15, 5, v1
    v_lshlrev_b32 v15, 3, v15
    v_bfe_u32 v13, v1, 2, 2
    v_add_u32 v15, v15, v13
    v_bfe_u32 v48, v1, 4, 1
    v_lshlrev_b32 v48, 5, v48
    v_and_b32 v49, 3, v1
    v_lshlrev_b32 v49, 3, v49
    v_add_u32 v48, v48, v49
    v_lshlrev_b32 v49, 6, v15
    v_add_u32 v49, v49, v48
    v_lshlrev_b32 v15, 7, v15
    v_add_u32 v15, v15, v48
    v_bfe_u32 v48, v1, 3, 1
    v_lshlrev_b32 v48, 6, v48
    v_add_u32 v15, v15, v48
    s_add_u32 s29, s27, 0
    s_and_b32 s29, s29, 3
    s_lshl_b32 s30, s29, 5
    s_lshl_b32 s31, s29, 11
    s_lshl_b32 s32, s29, 10
    v_xor_b32 v4, s30, v14
    v_add_u32 v8, s31, v15
    v_add_u32 v130, s32, v49
    s_add_u32 s29, s27, 1
    s_and_b32 s29, s29, 3
    s_lshl_b32 s30, s29, 5
    s_lshl_b32 s31, s29, 11
    s_lshl_b32 s32, s29, 10
    v_xor_b32 v5, s30, v14
    v_add_u32 v9, s31, v15
    v_add_u32 v131, s32, v49
    s_add_u32 s29, s27, 2
    s_and_b32 s29, s29, 3
    s_lshl_b32 s30, s29, 5
    s_lshl_b32 s31, s29, 11
    s_lshl_b32 s32, s29, 10
    v_xor_b32 v6, s30, v14
    v_add_u32 v10, s31, v15
    v_add_u32 v141, s32, v49
    s_add_u32 s29, s27, 3
    s_and_b32 s29, s29, 3
    s_lshl_b32 s30, s29, 5
    s_lshl_b32 s31, s29, 11
    s_lshl_b32 s32, s29, 10
    v_xor_b32 v7, s30, v14
    v_add_u32 v11, s31, v15
    v_add_u32 v142, s32, v49
    v_mov_b32 v64, 0
    v_mov_b32 v65, 0
    v_mov_b32 v66, 0
    v_mov_b32 v67, 0
    v_mov_b32 v68, 0
    v_mov_b32 v69, 0
    v_mov_b32 v70, 0
    v_mov_b32 v71, 0
    v_mov_b32 v72, 0
    v_mov_b32 v73, 0
    v_mov_b32 v74, 0
    v_mov_b32 v75, 0
    v_mov_b32 v76, 0
    v_mov_b32 v77, 0
    v_mov_b32 v78, 0
    v_mov_b32 v79, 0
    v_mov_b32 v160, 0
    v_mov_b32 v161, 0
    v_mov_b32 v162, 0
    v_mov_b32 v163, 0
    v_mov_b32 v164, 0
    v_mov_b32 v165, 0
    v_mov_b32 v166, 0
    v_mov_b32 v167, 0
    v_mov_b32 v168, 0
    v_mov_b32 v169, 0
    v_mov_b32 v170, 0
    v_mov_b32 v171, 0
    v_mov_b32 v172, 0
    v_mov_b32 v173, 0
    v_mov_b32 v174, 0
    v_mov_b32 v175, 0
    v_mov_b32 v80, 0
    v_mov_b32 v81, 0
    v_mov_b32 v82, 0
    v_mov_b32 v83, 0
    v_mov_b32 v84, 0
    v_mov_b32 v85, 0
    v_mov_b32 v86, 0
    v_mov_b32 v87, 0
    v_mov_b32 v88, 0
    v_mov_b32 v89, 0
    v_mov_b32 v90, 0
    v_mov_b32 v91, 0
    v_mov_b32 v92, 0
    v_mov_b32 v93, 0
    v_mov_b32 v94, 0
    v_mov_b32 v95, 0
    v_mov_b32 v176, 0
    v_mov_b32 v177, 0
    v_mov_b32 v178, 0
    v_mov_b32 v179, 0
    v_mov_b32 v180, 0
    v_mov_b32 v181, 0
    v_mov_b32 v182, 0
    v_mov_b32 v183, 0
    v_mov_b32 v184, 0
    v_mov_b32 v185, 0
    v_mov_b32 v186, 0
    v_mov_b32 v187, 0
    v_mov_b32 v188, 0
    v_mov_b32 v189, 0
    v_mov_b32 v190, 0
    v_mov_b32 v191, 0
    v_mov_b32 v96, 0
    v_mov_b32 v97, 0
    v_mov_b32 v98, 0
    v_mov_b32 v99, 0
    v_mov_b32 v100, 0
    v_mov_b32 v101, 0
    v_mov_b32 v102, 0
    v_mov_b32 v103, 0
    v_mov_b32 v104, 0
    v_mov_b32 v105, 0
    v_mov_b32 v106, 0
    v_mov_b32 v107, 0
    v_mov_b32 v108, 0
    v_mov_b32 v109, 0
    v_mov_b32 v110, 0
    v_mov_b32 v111, 0
    v_mov_b32 v192, 0
    v_mov_b32 v193, 0
    v_mov_b32 v194, 0
    v_mov_b32 v195, 0
    v_mov_b32 v196, 0
    v_mov_b32 v197, 0
    v_mov_b32 v198, 0
    v_mov_b32 v199, 0
    v_mov_b32 v200, 0
    v_mov_b32 v201, 0
    v_mov_b32 v202, 0
    v_mov_b32 v203, 0
    v_mov_b32 v204, 0
    v_mov_b32 v205, 0
    v_mov_b32 v206, 0
    v_mov_b32 v207, 0
    v_mov_b32 v208, 0
    v_mov_b32 v210, 0
    v_mov_b32 v209, 0
    v_mov_b32 v211, 0
    v_mov_b32 v220, 0x3f803f80
    v_mov_b32 v221, 0x3f803f80
    v_mov_b32 v222, 0x3f803f80
    v_mov_b32 v223, 0x3f803f80
    s_waitcnt vmcnt(10)
    s_barrier
    s_mov_b32 s36, 0
    s_mov_b32 s37, 0
    s_mov_b32 s38, 36864
    v_add_u32 v12, s37, v4
    v_add_u32 v13, s37, v8
    ds_read_b128 v[16:19], v12
    ds_read_b64_tr_b16 v[24:25], v13 offset:16384
    ds_read_b64_tr_b16 v[26:27], v13 offset:16896
    v_xor_b32 v48, 64, v13
    ds_read_b64_tr_b16 v[28:29], v48 offset:16384
    ds_read_b64_tr_b16 v[30:31], v48 offset:16896
    v_add_u32 v49, s37, v130
    ds_read_b64_tr_b16 v[32:33], v49 offset:24576
    ds_read_b64_tr_b16 v[34:35], v49 offset:24832
    v_add_u32 v12, s37, v5
    v_add_u32 v53, s37, v9
    ds_read_b128 v[20:23], v12
    ds_read_b64_tr_b16 v[36:37], v53 offset:16384
    ds_read_b64_tr_b16 v[38:39], v53 offset:16896
    v_xor_b32 v48, 64, v53
    ds_read_b64_tr_b16 v[40:41], v48 offset:16384
    ds_read_b64_tr_b16 v[42:43], v48 offset:16896
    v_add_u32 v49, s37, v131
    ds_read_b64_tr_b16 v[44:45], v49 offset:24576
    ds_read_b64_tr_b16 v[46:47], v49 offset:24832
L_p1_kernel_r0:
    s_waitcnt lgkmcnt(11)
    v_mfma_f32_32x32x16_bf16 v[64:79], v[24:27], v[16:19], v[64:79]
    v_add_u32 v12, s37, v6
    v_add_u32 v13, s37, v10
    ds_read_b128 v[224:227], v12
    ds_read_b64_tr_b16 v[232:233], v13 offset:16384
    ds_read_b64_tr_b16 v[234:235], v13 offset:16896
    v_lshlrev_b32 v212, 16, v16
    v_and_b32 v213, 0xffff0000, v16
    v_lshlrev_b32 v214, 16, v17
    v_and_b32 v215, 0xffff0000, v17
    s_waitcnt lgkmcnt(12)
    v_mfma_f32_32x32x16_bf16 v[80:95], v[28:31], v[16:19], v[80:95]
    v_xor_b32 v48, 64, v13
    ds_read_b64_tr_b16 v[236:237], v48 offset:16384
    ds_read_b64_tr_b16 v[238:239], v48 offset:16896
    v_add_f32 v208, v208, v212
    v_add_f32 v209, v209, v213
    v_fma_f32 v210, v212, v212, v210
    v_fma_f32 v211, v213, v213, v211
    s_waitcnt lgkmcnt(12)
    v_mfma_f32_32x32x16_bf16 v[96:111], v[32:35], v[16:19], v[96:111]
    v_add_u32 v49, s37, v141
    ds_read_b64_tr_b16 v[240:241], v49 offset:24576
    ds_read_b64_tr_b16 v[242:243], v49 offset:24832
    v_add_f32 v208, v208, v214
    v_add_f32 v209, v209, v215
    v_fma_f32 v210, v214, v214, v210
    v_fma_f32 v211, v215, v215, v211
    v_mfma_f32_32x32x16_bf16 v[160:175], v[220:223], v[24:27], v[160:175]
    v_mfma_f32_32x32x16_bf16 v[176:191], v[220:223], v[28:31], v[176:191]
    v_mfma_f32_32x32x16_bf16 v[192:207], v[220:223], v[32:35], v[192:207]
    s_waitcnt lgkmcnt(11)
    v_mfma_f32_32x32x16_bf16 v[64:79], v[36:39], v[20:23], v[64:79]
    v_add_u32 v12, s37, v7
    v_add_u32 v53, s37, v11
    ds_read_b128 v[228:231], v12
    ds_read_b64_tr_b16 v[244:245], v53 offset:16384
    ds_read_b64_tr_b16 v[246:247], v53 offset:16896
    v_lshlrev_b32 v212, 16, v20
    v_and_b32 v213, 0xffff0000, v20
    v_lshlrev_b32 v214, 16, v21
    v_and_b32 v215, 0xffff0000, v21
    s_waitcnt lgkmcnt(12)
    v_mfma_f32_32x32x16_bf16 v[80:95], v[40:43], v[20:23], v[80:95]
    v_xor_b32 v48, 64, v53
    ds_read_b64_tr_b16 v[248:249], v48 offset:16384
    ds_read_b64_tr_b16 v[250:251], v48 offset:16896
    v_add_f32 v208, v208, v212
    v_add_f32 v209, v209, v213
    v_fma_f32 v210, v212, v212, v210
    v_fma_f32 v211, v213, v213, v211
    s_waitcnt lgkmcnt(12)
    v_mfma_f32_32x32x16_bf16 v[96:111], v[44:47], v[20:23], v[96:111]
    v_add_u32 v49, s37, v142
    ds_read_b64_tr_b16 v[252:253], v49 offset:24576
    ds_read_b64_tr_b16 v[254:255], v49 offset:24832
    v_add_f32 v208, v208, v214
    v_add_f32 v209, v209, v215
    v_fma_f32 v210, v214, v214, v210
    v_fma_f32 v211, v215, v215, v211
    s_waitcnt vmcnt(5)
    s_barrier
    s_add_u32 s29, s36, 3
    s_and_b32 s29, s29, 3
    s_mul_i32 s29, s29, 36864
    s_waitcnt lgkmcnt(11)
    v_mfma_f32_32x32x16_bf16 v[64:79], v[232:235], v[224:227], v[64:79]
    v_add_u32 v12, s38, v4
    v_add_u32 v13, s38, v8
    ds_read_b128 v[16:19], v12
    ds_read_b64_tr_b16 v[24:25], v13 offset:16384
    ds_read_b64_tr_b16 v[26:27], v13 offset:16896
    s_lshl_b32 s40, s26, 11
    s_add_u32 s40, s40, s29
    s_add_u32 m0, s40, 0
    s_nop 0
    buffer_load_dwordx4 v2, s[16:19], s39 offen lds
    v_lshlrev_b32 v212, 16, v224
    v_and_b32 v213, 0xffff0000, v224
    v_lshlrev_b32 v214, 16, v225
    v_and_b32 v215, 0xffff0000, v225
    s_waitcnt lgkmcnt(12)
    v_mfma_f32_32x32x16_bf16 v[80:95], v[236:239], v[224:227], v[80:95]
    v_xor_b32 v48, 64, v13
    ds_read_b64_tr_b16 v[28:29], v48 offset:16384
    ds_read_b64_tr_b16 v[30:31], v48 offset:16896
    s_add_u32 m0, s40, 1024
    s_nop 0
    buffer_load_dwordx4 v3, s[16:19], s39 offen lds
    s_add_u32 s39, s39, 128
    v_add_f32 v208, v208, v212
    v_add_f32 v209, v209, v213
    v_fma_f32 v210, v212, v212, v210
    v_fma_f32 v211, v213, v213, v211
    s_waitcnt lgkmcnt(12)
    v_mfma_f32_32x32x16_bf16 v[96:111], v[240:243], v[224:227], v[96:111]
    v_add_u32 v49, s38, v130
    ds_read_b64_tr_b16 v[32:33], v49 offset:24576
    ds_read_b64_tr_b16 v[34:35], v49 offset:24832
    s_lshl_b32 s40, s27, 11
    s_add_u32 s40, s40, s29
    s_add_u32 m0, s40, 16384
    s_nop 0
    global_load_lds_dwordx4 v[54:55], off
    v_add_co_u32 v54, vcc, s41, v54
    v_addc_co_u32 v55, vcc, 0, v55, vcc
    v_add_f32 v208, v208, v214
    v_add_f32 v209, v209, v215
    v_fma_f32 v210, v214, v214, v210
    v_fma_f32 v211, v215, v215, v211
    s_waitcnt lgkmcnt(11)
    v_mfma_f32_32x32x16_bf16 v[64:79], v[244:247], v[228:231], v[64:79]
    v_add_u32 v12, s38, v5
    v_add_u32 v53, s38, v9
    ds_read_b128 v[20:23], v12
    ds_read_b64_tr_b16 v[36:37], v53 offset:16384
    ds_read_b64_tr_b16 v[38:39], v53 offset:16896
    s_add_u32 m0, s40, 17408
    s_nop 0
    global_load_lds_dwordx4 v[56:57], off
    v_add_co_u32 v56, vcc, s42, v56
    v_addc_co_u32 v57, vcc, 0, v57, vcc
    v_lshlrev_b32 v212, 16, v228
    v_and_b32 v213, 0xffff0000, v228
    v_lshlrev_b32 v214, 16, v229
    v_and_b32 v215, 0xffff0000, v229
    s_waitcnt lgkmcnt(12)
    v_mfma_f32_32x32x16_bf16 v[80:95], v[248:251], v[228:231], v[80:95]
    v_xor_b32 v48, 64, v53
    ds_read_b64_tr_b16 v[40:41], v48 offset:16384
    ds_read_b64_tr_b16 v[42:43], v48 offset:16896
    s_lshl_b32 s40, s27, 10
    s_add_u32 s40, s40, s29
    s_add_u32 m0, s40, 24576
    s_nop 0
    global_load_lds_dwordx4 v[58:59], off
    v_add_co_u32 v58, vcc, s43, v58
    v_addc_co_u32 v59, vcc, 0, v59, vcc
    v_add_f32 v208, v208, v212
    v_add_f32 v209, v209, v213
    v_fma_f32 v210, v212, v212, v210
    v_fma_f32 v211, v213, v213, v211
    s_waitcnt lgkmcnt(12)
    v_mfma_f32_32x32x16_bf16 v[96:111], v[252:255], v[228:231], v[96:111]
    v_add_u32 v49, s38, v131
    ds_read_b64_tr_b16 v[44:45], v49 offset:24576
    ds_read_b64_tr_b16 v[46:47], v49 offset:24832
    v_add_f32 v208, v208, v214
    v_add_f32 v209, v209, v215
    v_fma_f32 v210, v214, v214, v210
    v_fma_f32 v211, v215, v215, v211
    s_add_u32 s36, s36, 1
    s_mov_b32 s37, s38
    s_add_u32 s29, s36, 1
    s_and_b32 s29, s29, 3
    s_mul_i32 s38, s29, 36864
    s_cmp_lt_u32 s36, 5
    s_cbranch_scc1 L_p1_kernel_r0
    s_load_dwordx2 s[48:49], s[0:1], 56
    s_load_dwordx2 s[50:51], s[0:1], 32
    s_load_dwordx2 s[52:53], s[0:1], 72
    s_lshl_b32 s29, s2, 2
    s_add_u32 s29, s29, s27
    s_lshl_b32 s29, s29, 13
    v_lshlrev_b32 v132, 7, v1
    v_add_u32 v132, s29, v132
    s_waitcnt lgkmcnt(0)
    global_load_dword v134, v132, s[48:49]
    s_lshl_b32 s29, s2, 2
    s_add_u32 s29, s29, s27
    s_mul_i32 s29, s29, 11
    v_min_u32 v132, 10, v1
    v_add_u32 v132, s29, v132
    v_cmp_gt_u32 vcc, 4096, v132
    v_subrev_u32 v133, 4096, v132
    v_mov_b32 v136, s52
    v_mov_b32 v137, s53
    v_mov_b32 v138, s50
    v_mov_b32 v139, s51
    v_cndmask_b32 v132, v133, v132, vcc
    v_cndmask_b32 v136, v136, v138, vcc
    v_cndmask_b32 v137, v137, v139, vcc
    v_lshlrev_b32 v132, 7, v132
    v_add_co_u32 v136, vcc, v136, v132
    v_addc_co_u32 v137, vcc, 0, v137, vcc
    global_load_dword v135, v[136:137], off
    s_getpc_b64 s[48:49]
L_p1_kernel_pc:
    s_add_u32 s48, s48, p23_kernel-L_p1_kernel_pc-1024
    s_addc_u32 s49, s49, 0
    s_mul_i32 s29, s27, 12288
    v_mul_u32_u24 v132, 192, v1
    v_add_u32 v132, s29, v132
    v_min_u32 v132, p23_kernel_codeend-p23_kernel+1020, v132
    global_load_dword v143, v132, s[48:49]
L_p1_kernel_r0_b:
    s_waitcnt lgkmcnt(11)
    v_mfma_f32_32x32x16_bf16 v[64:79], v[24:27], v[16:19], v[64:79]
    v_add_u32 v12, s37, v6
    v_add_u32 v13, s37, v10
    ds_read_b128 v[224:227], v12
    ds_read_b64_tr_b16 v[232:233], v13 offset:16384
    ds_read_b64_tr_b16 v[234:235], v13 offset:16896
    v_lshlrev_b32 v212, 16, v16
    v_and_b32 v213, 0xffff0000, v16
    v_lshlrev_b32 v214, 16, v17
    v_and_b32 v215, 0xffff0000, v17
    s_waitcnt lgkmcnt(12)
    v_mfma_f32_32x32x16_bf16 v[80:95], v[28:31], v[16:19], v[80:95]
    v_xor_b32 v48, 64, v13
    ds_read_b64_tr_b16 v[236:237], v48 offset:16384
    ds_read_b64_tr_b16 v[238:239], v48 offset:16896
    v_add_f32 v208, v208, v212
    v_add_f32 v209, v209, v213
    v_fma_f32 v210, v212, v212, v210
    v_fma_f32 v211, v213, v213, v211
    s_waitcnt lgkmcnt(12)
    v_mfma_f32_32x32x16_bf16 v[96:111], v[32:35], v[16:19], v[96:111]
    v_add_u32 v49, s37, v141
    ds_read_b64_tr_b16 v[240:241], v49 offset:24576
    ds_read_b64_tr_b16 v[242:243], v49 offset:24832
    v_add_f32 v208, v208, v214
    v_add_f32 v209, v209, v215
    v_fma_f32 v210, v214, v214, v210
    v_fma_f32 v211, v215, v215, v211
    v_mfma_f32_32x32x16_bf16 v[160:175], v[220:223], v[24:27], v[160:175]
    v_mfma_f32_32x32x16_bf16 v[176:191], v[220:223], v[28:31], v[176:191]
    v_mfma_f32_32x32x16_bf16 v[192:207], v[220:223], v[32:35], v[192:207]
    s_waitcnt lgkmcnt(11)
    v_mfma_f32_32x32x16_bf16 v[64:79], v[36:39], v[20:23], v[64:79]
    v_add_u32 v12, s37, v7
    v_add_u32 v53, s37, v11
    ds_read_b128 v[228:231], v12
    ds_read_b64_tr_b16 v[244:245], v53 offset:16384
    ds_read_b64_tr_b16 v[246:247], v53 offset:16896
    v_lshlrev_b32 v212, 16, v20
    v_and_b32 v213, 0xffff0000, v20
    v_lshlrev_b32 v214, 16, v21
    v_and_b32 v215, 0xffff0000, v21
    s_waitcnt lgkmcnt(12)
    v_mfma_f32_32x32x16_bf16 v[80:95], v[40:43], v[20:23], v[80:95]
    v_xor_b32 v48, 64, v53
    ds_read_b64_tr_b16 v[248:249], v48 offset:16384
    ds_read_b64_tr_b16 v[250:251], v48 offset:16896
    v_add_f32 v208, v208, v212
    v_add_f32 v209, v209, v213
    v_fma_f32 v210, v212, v212, v210
    v_fma_f32 v211, v213, v213, v211
    s_waitcnt lgkmcnt(12)
    v_mfma_f32_32x32x16_bf16 v[96:111], v[44:47], v[20:23], v[96:111]
    v_add_u32 v49, s37, v142
    ds_read_b64_tr_b16 v[252:253], v49 offset:24576
    ds_read_b64_tr_b16 v[254:255], v49 offset:24832
    v_add_f32 v208, v208, v214
    v_add_f32 v209, v209, v215
    v_fma_f32 v210, v214, v214, v210
    v_fma_f32 v211, v215, v215, v211
    s_cmp_eq_u32 s36, 7
    s_cbranch_scc1 L_p1_kernel_r0_b_nob
    s_cmp_eq_u32 s36, 6
    s_cbranch_scc1 L_p1_kernel_r0_b_w0
    s_waitcnt vmcnt(8)
    s_branch L_p1_kernel_r0_b_bar
L_p1_kernel_r0_b_w0:
    s_waitcnt vmcnt(3)
L_p1_kernel_r0_b_bar:
    s_barrier
L_p1_kernel_r0_b_nob:
    s_waitcnt lgkmcnt(11)
    v_mfma_f32_32x32x16_bf16 v[64:79], v[232:235], v[224:227], v[64:79]
    v_add_u32 v12, s38, v4
    v_add_u32 v13, s38, v8
    ds_read_b128 v[16:19], v12
    ds_read_b64_tr_b16 v[24:25], v13 offset:16384
    ds_read_b64_tr_b16 v[26:27], v13 offset:16896
    v_lshlrev_b32 v212, 16, v224
    v_and_b32 v213, 0xffff0000, v224
    v_lshlrev_b32 v214, 16, v225
    v_and_b32 v215, 0xffff0000, v225
    s_waitcnt lgkmcnt(12)
    v_mfma_f32_32x32x16_bf16 v[80:95], v[236:239], v[224:227], v[80:95]
    v_xor_b32 v48, 64, v13
    ds_read_b64_tr_b16 v[28:29], v48 offset:16384
    ds_read_b64_tr_b16 v[30:31], v48 offset:16896
    v_add_f32 v208, v208, v212
    v_add_f32 v209, v209, v213
    v_fma_f32 v210, v212, v212, v210
    v_fma_f32 v211, v213, v213, v211
    s_waitcnt lgkmcnt(12)
    v_mfma_f32_32x32x16_bf16 v[96:111], v[240:243], v[224:227], v[96:111]
    v_add_u32 v49, s38, v130
    ds_read_b64_tr_b16 v[32:33], v49 offset:24576
    ds_read_b64_tr_b16 v[34:35], v49 offset:24832
    v_add_f32 v208, v208, v214
    v_add_f32 v209, v209, v215
    v_fma_f32 v210, v214, v214, v210
    v_fma_f32 v211, v215, v215, v211
    s_waitcnt lgkmcnt(11)
    v_mfma_f32_32x32x16_bf16 v[64:79], v[244:247], v[228:231], v[64:79]
    v_add_u32 v12, s38, v5
    v_add_u32 v53, s38, v9
    ds_read_b128 v[20:23], v12
    ds_read_b64_tr_b16 v[36:37], v53 offset:16384
    ds_read_b64_tr_b16 v[38:39], v53 offset:16896
    v_lshlrev_b32 v212, 16, v228
    v_and_b32 v213, 0xffff0000, v228
    v_lshlrev_b32 v214, 16, v229
    v_and_b32 v215, 0xffff0000, v229
    s_waitcnt lgkmcnt(12)
    v_mfma_f32_32x32x16_bf16 v[80:95], v[248:251], v[228:231], v[80:95]
    v_xor_b32 v48, 64, v53
    ds_read_b64_tr_b16 v[40:41], v48 offset:16384
    ds_read_b64_tr_b16 v[42:43], v48 offset:16896
    v_add_f32 v208, v208, v212
    v_add_f32 v209, v209, v213
    v_fma_f32 v210, v212, v212, v210
    v_fma_f32 v211, v213, v213, v211
    s_waitcnt lgkmcnt(12)
    v_mfma_f32_32x32x16_bf16 v[96:111], v[252:255], v[228:231], v[96:111]
    v_add_u32 v49, s38, v131
    ds_read_b64_tr_b16 v[44:45], v49 offset:24576
    ds_read_b64_tr_b16 v[46:47], v49 offset:24832
    v_add_f32 v208, v208, v214
    v_add_f32 v209, v209, v215
    v_fma_f32 v210, v214, v214, v210
    v_fma_f32 v211, v215, v215, v211
    s_add_u32 s36, s36, 1
    s_mov_b32 s37, s38
    s_add_u32 s29, s36, 1
    s_and_b32 s29, s29, 3
    s_mul_i32 s38, s29, 36864
    s_cmp_lt_u32 s36, 8
    s_cbranch_scc1 L_p1_kernel_r0_b
    s_waitcnt lgkmcnt(0)
    v_add_f32 v51, v208, v209
    v_add_f32 v52, v210, v211
    v_mov_b32 v14, v51
    v_mov_b32 v15, v52
    s_nop 0
    v_permlane32_swap_b32 v14, v51
    v_permlane32_swap_b32 v15, v52
    s_nop 0
    v_add_f32 v62, v51, v14
    v_add_f32 v63, v52, v15
    v_and_b32 v14, 31, v1
    s_lshl_b32 s29, s27, 5
    v_add_u32 v15, s29, v14
    v_lshlrev_b32 v15, 3, v15
    v_add_u32 v15, 147456, v15
    ds_write_b64 v15, v[62:63] offset:0
    v_lshlrev_b32 v14, 4, v14
    v_add_u32 v14, 149504, v14
    s_lshl_b32 s29, s27, 2
    v_add_u32 v12, s29, v14
    ds_write_b32 v12, v160 offset:0
    ds_write_b32 v12, v176 offset:512
    ds_write_b32 v12, v192 offset:1024
    s_waitcnt lgkmcnt(0)
    s_barrier
    ds_read_b64 v[62:63], v15
    ds_read_b64 v[52:53], v15 offset:1024
    ds_read_b128 v[16:19], v14 offset:0
    ds_read_b128 v[20:23], v14 offset:512
    ds_read_b128 v[24:27], v14 offset:1024
    v_cmp_gt_u32 vcc, 32, v1
    v_mov_b32 v30, 0
    v_mov_b32 v31, 0
    v_mov_b32 v34, 0
    v_mov_b32 v35, 0
    v_mov_b32 v38, 0
    v_mov_b32 v39, 0
    v_mov_b32 v42, 0
    v_mov_b32 v43, 0
    s_waitcnt lgkmcnt(3)
    v_add_f32 v62, v62, v52
    v_add_f32 v63, v63, v53
    v_mul_f32 v62, 0xbb000000, v62
    v_mul_f32 v63, 0x3b000000, v63
    v_cvt_pk_bf16_f32 v28, v62, v62
    v_fma_f32 v63, -v62, v62, v63
    v_and_b32 v15, 0xffff0000, v28
    v_max_f32 v63, 0, v63
    v_sub_f32 v15, v62, v15
    v_add_f32 v63, 0x3727c5ac, v63
    v_cvt_pk_bf16_f32 v29, v15, 0
    v_rsq_f32 v60, v63
    v_cndmask_b32 v28, 0, v28, vcc
    v_cndmask_b32 v29, 0, v29, vcc
    s_waitcnt lgkmcnt(0)
    v_add_f32 v16, v16, v17
    v_add_f32 v18, v18, v19
    v_add_f32 v20, v20, v21
    v_add_f32 v22, v22, v23
    v_add_f32 v24, v24, v25
    v_add_f32 v26, v26, v27
    v_add_f32 v16, v16, v18
    v_add_f32 v20, v20, v22
    v_add_f32 v24, v24, v26
    v_cvt_pk_bf16_f32 v33, v16, 0
    v_cvt_pk_bf16_f32 v37, v20, 0
    v_cvt_pk_bf16_f32 v41, v24, 0
    v_lshlrev_b32 v17, 16, v33
    v_lshlrev_b32 v21, 16, v37
    v_lshlrev_b32 v25, 16, v41
    v_sub_f32 v17, v16, v17
    v_sub_f32 v21, v20, v21
    v_sub_f32 v25, v24, v25
    v_cvt_pk_bf16_f32 v32, v16, v17
    v_cvt_pk_bf16_f32 v36, v20, v21
    v_cvt_pk_bf16_f32 v40, v24, v25
    v_cndmask_b32 v32, 0, v32, vcc
    v_cndmask_b32 v33, 0, v33, vcc
    v_cndmask_b32 v36, 0, v36, vcc
    v_cndmask_b32 v37, 0, v37, vcc
    v_cndmask_b32 v40, 0, v40, vcc
    v_cndmask_b32 v41, 0, v41, vcc
    s_nop 1
    v_mfma_f32_32x32x16_bf16 v[64:79], v[32:35], v[28:31], v[64:79]
    v_mfma_f32_32x32x16_bf16 v[80:95], v[36:39], v[28:31], v[80:95]
    v_mfma_f32_32x32x16_bf16 v[96:111], v[40:43], v[28:31], v[96:111]
    v_mul_f32 v44, 0xc0135761, v60
    v_mul_f32 v46, v60, v60
    v_mul_f32 v48, v63, v60
    v_mul_f32 v46, v46, v60
    v_mul_f32 v46, 0xbdd2d3e8, v46
    s_nop 9
    v_mul_f32 v61, 0x3eb8aa3b, v60
    v_pk_mul_f32 v[96:97], v[96:97], v[60:61] op_sel:[0,1] op_sel_hi:[1,1]
    v_pk_mul_f32 v[98:99], v[98:99], v[60:61] op_sel:[0,1] op_sel_hi:[1,1]
    v_pk_mul_f32 v[100:101], v[100:101], v[60:61] op_sel:[0,1] op_sel_hi:[1,1]
    v_pk_mul_f32 v[102:103], v[102:103], v[60:61] op_sel:[0,1] op_sel_hi:[1,1]
    v_pk_mul_f32 v[104:105], v[104:105], v[60:61] op_sel:[0,1] op_sel_hi:[1,1]
    v_pk_mul_f32 v[106:107], v[106:107], v[60:61] op_sel:[0,1] op_sel_hi:[1,1]
    v_pk_mul_f32 v[108:109], v[108:109], v[60:61] op_sel:[0,1] op_sel_hi:[1,1]
    v_pk_mul_f32 v[110:111], v[110:111], v[60:61] op_sel:[0,1] op_sel_hi:[1,1]
    v_cvt_pk_bf16_f32 v144, v96, v97
    v_cvt_pk_bf16_f32 v145, v98, v99
    v_cvt_pk_bf16_f32 v146, v100, v101
    v_cvt_pk_bf16_f32 v147, v102, v103
    v_cvt_pk_bf16_f32 v148, v104, v105
    v_cvt_pk_bf16_f32 v149, v106, v107
    v_cvt_pk_bf16_f32 v150, v108, v109
    v_cvt_pk_bf16_f32 v151, v110, v111
    s_lshl_b32 s29, s46, 5
    s_lshl_b32 s30, s25, 1
    s_add_u32 s29, s29, s30
    s_lshl_b32 s29, s29, 10
    s_add_u32 s29, s29, 0
    v_lshlrev_b32 v140, 4, v1
    buffer_store_dwordx4 v[144:147], v140, s[20:23], s29 offen sc1
    buffer_store_dwordx4 v[148:151], v140, s[20:23], s29 offen offset:1024 sc1
    s_cmp_lt_u32 s25, 14
    s_cbranch_scc0 L_p1_kernel_notz1
    s_lshl_b32 s32, s25, 1
    v_pk_mul_f32 v[112:113], v[64:65], v[64:65]
    v_pk_mul_f32 v[114:115], v[66:67], v[66:67]
    v_pk_mul_f32 v[116:117], v[68:69], v[68:69]
    v_pk_mul_f32 v[118:119], v[70:71], v[70:71]
    v_pk_mul_f32 v[120:121], v[72:73], v[72:73]
    v_pk_mul_f32 v[122:123], v[74:75], v[74:75]
    v_pk_mul_f32 v[124:125], v[76:77], v[76:77]
    v_pk_mul_f32 v[126:127], v[78:79], v[78:79]
    v_pk_fma_f32 v[112:113], v[112:113], v[46:47], v[44:45] op_sel_hi:[1,0,0]
    v_pk_fma_f32 v[114:115], v[114:115], v[46:47], v[44:45] op_sel_hi:[1,0,0]
    v_pk_fma_f32 v[116:117], v[116:117], v[46:47], v[44:45] op_sel_hi:[1,0,0]
    v_pk_fma_f32 v[118:119], v[118:119], v[46:47], v[44:45] op_sel_hi:[1,0,0]
    v_pk_fma_f32 v[120:121], v[120:121], v[46:47], v[44:45] op_sel_hi:[1,0,0]
    v_pk_fma_f32 v[122:123], v[122:123], v[46:47], v[44:45] op_sel_hi:[1,0,0]
    v_pk_fma_f32 v[124:125], v[124:125], v[46:47], v[44:45] op_sel_hi:[1,0,0]
    v_pk_fma_f32 v[126:127], v[126:127], v[46:47], v[44:45] op_sel_hi:[1,0,0]
    v_pk_mul_f32 v[112:113], v[112:113], v[64:65]
    v_pk_mul_f32 v[114:115], v[114:115], v[66:67]
    v_pk_mul_f32 v[116:117], v[116:117], v[68:69]
    v_pk_mul_f32 v[118:119], v[118:119], v[70:71]
    v_pk_mul_f32 v[120:121], v[120:121], v[72:73]
    v_pk_mul_f32 v[122:123], v[122:123], v[74:75]
    v_pk_mul_f32 v[124:125], v[124:125], v[76:77]
    v_pk_mul_f32 v[126:127], v[126:127], v[78:79]
    v_exp_f32 v112, v112
    v_exp_f32 v113, v113
    v_exp_f32 v114, v114
    v_exp_f32 v115, v115
    v_exp_f32 v116, v116
    v_exp_f32 v117, v117
    v_exp_f32 v118, v118
    v_exp_f32 v119, v119
    v_exp_f32 v120, v120
    v_exp_f32 v121, v121
    v_exp_f32 v122, v122
    v_exp_f32 v123, v123
    v_exp_f32 v124, v124
    v_exp_f32 v125, v125
    v_exp_f32 v126, v126
    v_exp_f32 v127, v127
    v_pk_fma_f32 v[112:113], v[112:113], v[48:49], v[48:49] op_sel_hi:[1,0,0]
    v_pk_fma_f32 v[114:115], v[114:115], v[48:49], v[48:49] op_sel_hi:[1,0,0]
    v_pk_fma_f32 v[116:117], v[116:117], v[48:49], v[48:49] op_sel_hi:[1,0,0]
    v_pk_fma_f32 v[118:119], v[118:119], v[48:49], v[48:49] op_sel_hi:[1,0,0]
    v_pk_fma_f32 v[120:121], v[120:121], v[48:49], v[48:49] op_sel_hi:[1,0,0]
    v_pk_fma_f32 v[122:123], v[122:123], v[48:49], v[48:49] op_sel_hi:[1,0,0]
    v_pk_fma_f32 v[124:125], v[124:125], v[48:49], v[48:49] op_sel_hi:[1,0,0]
    v_pk_fma_f32 v[126:127], v[126:127], v[48:49], v[48:49] op_sel_hi:[1,0,0]
    v_rcp_f32 v112, v112
    v_rcp_f32 v113, v113
    v_rcp_f32 v114, v114
    v_rcp_f32 v115, v115
    v_rcp_f32 v116, v116
    v_rcp_f32 v117, v117
    v_rcp_f32 v118, v118
    v_rcp_f32 v119, v119
    v_rcp_f32 v120, v120
    v_rcp_f32 v121, v121
    v_rcp_f32 v122, v122
    v_rcp_f32 v123, v123
    v_rcp_f32 v124, v124
    v_rcp_f32 v125, v125
    v_rcp_f32 v126, v126
    v_rcp_f32 v127, v127
    v_pk_mul_f32 v[64:65], v[64:65], v[112:113]
    v_pk_mul_f32 v[66:67], v[66:67], v[114:115]
    v_pk_mul_f32 v[68:69], v[68:69], v[116:117]
    v_pk_mul_f32 v[70:71], v[70:71], v[118:119]
    v_pk_mul_f32 v[72:73], v[72:73], v[120:121]
    v_pk_mul_f32 v[74:75], v[74:75], v[122:123]
    v_pk_mul_f32 v[76:77], v[76:77], v[124:125]
    v_pk_mul_f32 v[78:79], v[78:79], v[126:127]
    v_cvt_pk_bf16_f32 v144, v64, v65
    v_cvt_pk_bf16_f32 v145, v66, v67
    v_cvt_pk_bf16_f32 v146, v68, v69
    v_cvt_pk_bf16_f32 v147, v70, v71
    v_cvt_pk_bf16_f32 v148, v72, v73
    v_cvt_pk_bf16_f32 v149, v74, v75
    v_cvt_pk_bf16_f32 v150, v76, v77
    v_cvt_pk_bf16_f32 v151, v78, v79
    s_mul_i32 s29, s46, 28
    s_add_u32 s29, s29, s32
    s_lshl_b32 s29, s29, 11
    s_add_u32 s29, s29, 2621440
    v_lshlrev_b32 v140, 4, v1
    buffer_store_dwordx4 v[144:147], v140, s[20:23], s29 offen sc1
    buffer_store_dwordx4 v[148:151], v140, s[20:23], s29 offen offset:1024 sc1
    s_add_u32 s32, s32, 1
    v_pk_mul_f32 v[112:113], v[80:81], v[80:81]
    v_pk_mul_f32 v[114:115], v[82:83], v[82:83]
    v_pk_mul_f32 v[116:117], v[84:85], v[84:85]
    v_pk_mul_f32 v[118:119], v[86:87], v[86:87]
    v_pk_mul_f32 v[120:121], v[88:89], v[88:89]
    v_pk_mul_f32 v[122:123], v[90:91], v[90:91]
    v_pk_mul_f32 v[124:125], v[92:93], v[92:93]
    v_pk_mul_f32 v[126:127], v[94:95], v[94:95]
    v_pk_fma_f32 v[112:113], v[112:113], v[46:47], v[44:45] op_sel_hi:[1,0,0]
    v_pk_fma_f32 v[114:115], v[114:115], v[46:47], v[44:45] op_sel_hi:[1,0,0]
    v_pk_fma_f32 v[116:117], v[116:117], v[46:47], v[44:45] op_sel_hi:[1,0,0]
    v_pk_fma_f32 v[118:119], v[118:119], v[46:47], v[44:45] op_sel_hi:[1,0,0]
    v_pk_fma_f32 v[120:121], v[120:121], v[46:47], v[44:45] op_sel_hi:[1,0,0]
    v_pk_fma_f32 v[122:123], v[122:123], v[46:47], v[44:45] op_sel_hi:[1,0,0]
    v_pk_fma_f32 v[124:125], v[124:125], v[46:47], v[44:45] op_sel_hi:[1,0,0]
    v_pk_fma_f32 v[126:127], v[126:127], v[46:47], v[44:45] op_sel_hi:[1,0,0]
    v_pk_mul_f32 v[112:113], v[112:113], v[80:81]
    v_pk_mul_f32 v[114:115], v[114:115], v[82:83]
    v_pk_mul_f32 v[116:117], v[116:117], v[84:85]
    v_pk_mul_f32 v[118:119], v[118:119], v[86:87]
    v_pk_mul_f32 v[120:121], v[120:121], v[88:89]
    v_pk_mul_f32 v[122:123], v[122:123], v[90:91]
    v_pk_mul_f32 v[124:125], v[124:125], v[92:93]
    v_pk_mul_f32 v[126:127], v[126:127], v[94:95]
    v_exp_f32 v112, v112
    v_exp_f32 v113, v113
    v_exp_f32 v114, v114
    v_exp_f32 v115, v115
    v_exp_f32 v116, v116
    v_exp_f32 v117, v117
    v_exp_f32 v118, v118
    v_exp_f32 v119, v119
    v_exp_f32 v120, v120
    v_exp_f32 v121, v121
    v_exp_f32 v122, v122
    v_exp_f32 v123, v123
    v_exp_f32 v124, v124
    v_exp_f32 v125, v125
    v_exp_f32 v126, v126
    v_exp_f32 v127, v127
    v_pk_fma_f32 v[112:113], v[112:113], v[48:49], v[48:49] op_sel_hi:[1,0,0]
    v_pk_fma_f32 v[114:115], v[114:115], v[48:49], v[48:49] op_sel_hi:[1,0,0]
    v_pk_fma_f32 v[116:117], v[116:117], v[48:49], v[48:49] op_sel_hi:[1,0,0]
    v_pk_fma_f32 v[118:119], v[118:119], v[48:49], v[48:49] op_sel_hi:[1,0,0]
    v_pk_fma_f32 v[120:121], v[120:121], v[48:49], v[48:49] op_sel_hi:[1,0,0]
    v_pk_fma_f32 v[122:123], v[122:123], v[48:49], v[48:49] op_sel_hi:[1,0,0]
    v_pk_fma_f32 v[124:125], v[124:125], v[48:49], v[48:49] op_sel_hi:[1,0,0]
    v_pk_fma_f32 v[126:127], v[126:127], v[48:49], v[48:49] op_sel_hi:[1,0,0]
    v_rcp_f32 v112, v112
    v_rcp_f32 v113, v113
    v_rcp_f32 v114, v114
    v_rcp_f32 v115, v115
    v_rcp_f32 v116, v116
    v_rcp_f32 v117, v117
    v_rcp_f32 v118, v118
    v_rcp_f32 v119, v119
    v_rcp_f32 v120, v120
    v_rcp_f32 v121, v121
    v_rcp_f32 v122, v122
    v_rcp_f32 v123, v123
    v_rcp_f32 v124, v124
    v_rcp_f32 v125, v125
    v_rcp_f32 v126, v126
    v_rcp_f32 v127, v127
    v_pk_mul_f32 v[80:81], v[80:81], v[112:113]
    v_pk_mul_f32 v[82:83], v[82:83], v[114:115]
    v_pk_mul_f32 v[84:85], v[84:85], v[116:117]
    v_pk_mul_f32 v[86:87], v[86:87], v[118:119]
    v_pk_mul_f32 v[88:89], v[88:89], v[120:121]
    v_pk_mul_f32 v[90:91], v[90:91], v[122:123]
    v_pk_mul_f32 v[92:93], v[92:93], v[124:125]
    v_pk_mul_f32 v[94:95], v[94:95], v[126:127]
    v_cvt_pk_bf16_f32 v144, v80, v81
    v_cvt_pk_bf16_f32 v145, v82, v83
    v_cvt_pk_bf16_f32 v146, v84, v85
    v_cvt_pk_bf16_f32 v147, v86, v87
    v_cvt_pk_bf16_f32 v148, v88, v89
    v_cvt_pk_bf16_f32 v149, v90, v91
    v_cvt_pk_bf16_f32 v150, v92, v93
    v_cvt_pk_bf16_f32 v151, v94, v95
    s_mul_i32 s29, s46, 28
    s_add_u32 s29, s29, s32
    s_lshl_b32 s29, s29, 11
    s_add_u32 s29, s29, 2621440
    v_lshlrev_b32 v140, 4, v1
    buffer_store_dwordx4 v[144:147], v140, s[20:23], s29 offen sc1
    buffer_store_dwordx4 v[148:151], v140, s[20:23], s29 offen offset:1024 sc1
    s_branch L_p1_kernel_done
L_p1_kernel_notz1:
    s_cmp_eq_u32 s25, 14
    s_cbranch_scc0 L_p1_kernel_qonly
    v_pk_mul_f32 v[64:65], v[64:65], v[60:61] op_sel_hi:[1,0]
    v_pk_mul_f32 v[66:67], v[66:67], v[60:61] op_sel_hi:[1,0]
    v_pk_mul_f32 v[68:69], v[68:69], v[60:61] op_sel_hi:[1,0]
    v_pk_mul_f32 v[70:71], v[70:71], v[60:61] op_sel_hi:[1,0]
    v_pk_mul_f32 v[72:73], v[72:73], v[60:61] op_sel_hi:[1,0]
    v_pk_mul_f32 v[74:75], v[74:75], v[60:61] op_sel_hi:[1,0]
    v_pk_mul_f32 v[76:77], v[76:77], v[60:61] op_sel_hi:[1,0]
    v_pk_mul_f32 v[78:79], v[78:79], v[60:61] op_sel_hi:[1,0]
    v_mul_f32 v14, v64, v64
    v_fma_f32 v14, v65, v65, v14
    v_fma_f32 v14, v66, v66, v14
    v_fma_f32 v14, v67, v67, v14
    v_fma_f32 v14, v68, v68, v14
    v_fma_f32 v14, v69, v69, v14
    v_fma_f32 v14, v70, v70, v14
    v_fma_f32 v14, v71, v71, v14
    v_mov_b32 v15, v14
    s_nop 1
    v_permlane32_swap_b32 v15, v14
    s_nop 1
    v_add_f32 v14, v14, v15
    v_max3_f32 v15, abs(v72), abs(v73), abs(v74)
    v_max3_f32 v15, abs(v75), abs(v76), v15
    v_max3_f32 v15, abs(v77), abs(v78), v15
    v_max_f32 v15, abs(v79), v15
    s_nop 1
    v_max_f32_dpp v14, v14, v14 row_ror:8 row_mask:0xf bank_mask:0xf
    s_nop 1
    v_max_f32_dpp v14, v14, v14 row_ror:4 row_mask:0xf bank_mask:0xf
    s_nop 1
    v_max_f32_dpp v14, v14, v14 row_ror:2 row_mask:0xf bank_mask:0xf
    s_nop 1
    v_max_f32_dpp v14, v14, v14 row_ror:1 row_mask:0xf bank_mask:0xf
    v_mov_b32 v12, v14
    s_nop 1
    v_permlane16_swap_b32 v12, v14
    s_nop 1
    v_max_f32 v14, v14, v12
    v_mov_b32 v12, v14
    s_nop 1
    v_permlane32_swap_b32 v12, v14
    s_nop 1
    v_max_f32 v14, v14, v12
    s_nop 1
    v_max_f32_dpp v15, v15, v15 row_ror:8 row_mask:0xf bank_mask:0xf
    s_nop 1
    v_max_f32_dpp v15, v15, v15 row_ror:4 row_mask:0xf bank_mask:0xf
    s_nop 1
    v_max_f32_dpp v15, v15, v15 row_ror:2 row_mask:0xf bank_mask:0xf
    s_nop 1
    v_max_f32_dpp v15, v15, v15 row_ror:1 row_mask:0xf bank_mask:0xf
    v_mov_b32 v12, v15
    s_nop 1
    v_permlane16_swap_b32 v12, v15
    s_nop 1
    v_max_f32 v15, v15, v12
    v_mov_b32 v12, v15
    s_nop 1
    v_permlane32_swap_b32 v12, v15
    s_nop 1
    v_max_f32 v15, v15, v12
    s_lshl_b32 s29, s46, 2
    s_add_u32 s29, s29, 2228224
    v_mov_b32 v140, 0
    buffer_store_dword v14, v140, s[20:23], s29 offen sc1
    buffer_store_dword v15, v140, s[20:23], s29 offen offset:256 sc1
    v_cvt_pk_bf16_f32 v144, v64, v65
    v_cvt_pk_bf16_f32 v145, v66, v67
    v_cvt_pk_bf16_f32 v146, v68, v69
    v_cvt_pk_bf16_f32 v147, v70, v71
    v_cvt_pk_bf16_f32 v148, v72, v73
    v_cvt_pk_bf16_f32 v149, v74, v75
    v_cvt_pk_bf16_f32 v150, v76, v77
    v_cvt_pk_bf16_f32 v151, v78, v79
    s_lshl_b32 s29, s46, 10
    s_add_u32 s30, s29, 2097152
    v_lshlrev_b32 v140, 4, v1
    buffer_store_dwordx4 v[144:147], v140, s[20:23], s30 offen sc1
    v_and_b32 v14, 31, v1
    v_mul_u32_u24 v14, 40, v14
    v_lshrrev_b32 v15, 5, v1
    v_lshlrev_b32 v15, 3, v15
    v_add_u32 v14, v14, v15
    s_mul_i32 s31, s26, 2560
    s_add_u32 s31, s31, 40960
    v_add_u32 v14, s31, v14
    ds_write_b64 v14, v[148:149]
    ds_write_b64 v14, v[150:151] offset:16
    v_bfe_u32 v14, v1, 4, 1
    v_lshlrev_b32 v14, 4, v14
    v_lshrrev_b32 v15, 5, v1
    v_lshlrev_b32 v15, 2, v15
    v_add_u32 v14, v14, v15
    v_bfe_u32 v15, v1, 2, 2
    v_add_u32 v14, v14, v15
    v_mul_u32_u24 v14, 40, v14
    v_and_b32 v15, 3, v1
    v_lshlrev_b32 v15, 3, v15
    v_add_u32 v14, v14, v15
    v_add_u32 v14, s31, v14
    s_waitcnt lgkmcnt(0)
    ds_read_b64_tr_b16 v[152:153], v14
    ds_read_b64_tr_b16 v[154:155], v14 offset:320
    v_bfe_u32 v140, v1, 4, 1
    v_lshlrev_b32 v140, 9, v140
    v_lshrrev_b32 v15, 5, v1
    v_lshlrev_b32 v15, 8, v15
    v_add_u32 v140, v140, v15
    v_and_b32 v15, 15, v1
    v_lshlrev_b32 v15, 4, v15
    v_add_u32 v140, v140, v15
    s_add_u32 s30, s29, 2162688
    s_waitcnt lgkmcnt(0)
    buffer_store_dwordx4 v[152:155], v140, s[20:23], s30 offen sc1
L_p1_kernel_qonly:
    s_branch L_p1_kernel_done
L_p1_kernel_Y:
    s_mov_b32 s39, 0
    s_mov_b32 s29, 0
    s_lshl_b32 s40, s26, 11
    s_add_u32 s40, s40, s29
    s_add_u32 m0, s40, 0
    s_nop 0
    buffer_load_dwordx4 v2, s[16:19], s39 offen lds
    s_add_u32 m0, s40, 1024
    s_nop 0
    buffer_load_dwordx4 v3, s[16:19], s39 offen lds
    s_add_u32 s39, s39, 128
    s_lshl_b32 s40, s27, 11
    s_add_u32 s40, s40, s29
    s_add_u32 m0, s40, 28672
    s_nop 0
    global_load_lds_dwordx4 v[54:55], off
    v_add_co_u32 v54, vcc, s41, v54
    v_addc_co_u32 v55, vcc, 0, v55, vcc
    s_add_u32 m0, s40, 29696
    s_nop 0
    global_load_lds_dwordx4 v[56:57], off
    v_add_co_u32 v56, vcc, s42, v56
    v_addc_co_u32 v57, vcc, 0, v57, vcc
    s_mov_b32 s29, 36864
    s_lshl_b32 s40, s26, 11
    s_add_u32 s40, s40, s29
    s_add_u32 m0, s40, 0
    s_nop 0
    buffer_load_dwordx4 v2, s[16:19], s39 offen lds
    s_add_u32 m0, s40, 1024
    s_nop 0
    buffer_load_dwordx4 v3, s[16:19], s39 offen lds
    s_add_u32 s39, s39, 128
    s_lshl_b32 s40, s27, 11
    s_add_u32 s40, s40, s29
    s_add_u32 m0, s40, 28672
    s_nop 0
    global_load_lds_dwordx4 v[54:55], off
    v_add_co_u32 v54, vcc, s41, v54
    v_addc_co_u32 v55, vcc, 0, v55, vcc
    s_add_u32 m0, s40, 29696
    s_nop 0
    global_load_lds_dwordx4 v[56:57], off
    v_add_co_u32 v56, vcc, s42, v56
    v_addc_co_u32 v57, vcc, 0, v57, vcc
    s_mov_b32 s29, 73728
    s_lshl_b32 s40, s26, 11
    s_add_u32 s40, s40, s29
    s_add_u32 m0, s40, 0
    s_nop 0
    buffer_load_dwordx4 v2, s[16:19], s39 offen lds
    s_add_u32 m0, s40, 1024
    s_nop 0
    buffer_load_dwordx4 v3, s[16:19], s39 offen lds
    s_add_u32 s39, s39, 128
    s_lshl_b32 s40, s27, 11
    s_add_u32 s40, s40, s29
    s_add_u32 m0, s40, 28672
    s_nop 0
    global_load_lds_dwordx4 v[54:55], off
    v_add_co_u32 v54, vcc, s41, v54
    v_addc_co_u32 v55, vcc, 0, v55, vcc
    s_add_u32 m0, s40, 29696
    s_nop 0
    global_load_lds_dwordx4 v[56:57], off
    v_add_co_u32 v56, vcc, s42, v56
    v_addc_co_u32 v57, vcc, 0, v57, vcc
    v_and_b32 v14, 31, v1
    v_lshrrev_b32 v15, 1, v14
    v_and_b32 v15, 7, v15
    v_lshrrev_b32 v12, 5, v1
    v_xor_b32 v15, v15, v12
    v_lshlrev_b32 v15, 4, v15
    v_lshlrev_b32 v14, 7, v14
    v_add_u32 v14, v14, v15
    s_lshl_b32 s29, s27, 12
    v_add_u32 v14, s29, v14
    v_lshrrev_b32 v15, 5, v1
    v_lshlrev_b32 v15, 3, v15
    v_bfe_u32 v13, v1, 2, 2
    v_add_u32 v15, v15, v13
    v_bfe_u32 v48, v1, 4, 1
    v_lshlrev_b32 v48, 5, v48
    v_and_b32 v49, 3, v1
    v_lshlrev_b32 v49, 3, v49
    v_add_u32 v48, v48, v49
    v_lshlrev_b32 v49, 6, v15
    v_add_u32 v49, v49, v48
    v_lshlrev_b32 v15, 7, v15
    v_add_u32 v15, v15, v48
    v_bfe_u32 v48, v1, 3, 1
    v_lshlrev_b32 v48, 6, v48
    v_add_u32 v15, v15, v48
    s_add_u32 s29, s27, 0
    s_and_b32 s29, s29, 3
    s_lshl_b32 s30, s29, 5
    s_lshl_b32 s31, s29, 11
    s_lshl_b32 s32, s29, 10
    v_xor_b32 v4, s30, v14
    v_add_u32 v8, s31, v15
    v_add_u32 v130, s32, v49
    s_add_u32 s29, s27, 1
    s_and_b32 s29, s29, 3
    s_lshl_b32 s30, s29, 5
    s_lshl_b32 s31, s29, 11
    s_lshl_b32 s32, s29, 10
    v_xor_b32 v5, s30, v14
    v_add_u32 v9, s31, v15
    v_add_u32 v131, s32, v49
    s_add_u32 s29, s27, 2
    s_and_b32 s29, s29, 3
    s_lshl_b32 s30, s29, 5
    s_lshl_b32 s31, s29, 11
    s_lshl_b32 s32, s29, 10
    v_xor_b32 v6, s30, v14
    v_add_u32 v10, s31, v15
    v_add_u32 v141, s32, v49
    s_add_u32 s29, s27, 3
    s_and_b32 s29, s29, 3
    s_lshl_b32 s30, s29, 5
    s_lshl_b32 s31, s29, 11
    s_lshl_b32 s32, s29, 10
    v_xor_b32 v7, s30, v14
    v_add_u32 v11, s31, v15
    v_add_u32 v142, s32, v49
    v_mov_b32 v64, 0
    v_mov_b32 v65, 0
    v_mov_b32 v66, 0
    v_mov_b32 v67, 0
    v_mov_b32 v68, 0
    v_mov_b32 v69, 0
    v_mov_b32 v70, 0
    v_mov_b32 v71, 0
    v_mov_b32 v72, 0
    v_mov_b32 v73, 0
    v_mov_b32 v74, 0
    v_mov_b32 v75, 0
    v_mov_b32 v76, 0
    v_mov_b32 v77, 0
    v_mov_b32 v78, 0
    v_mov_b32 v79, 0
    v_mov_b32 v160, 0
    v_mov_b32 v161, 0
    v_mov_b32 v162, 0
    v_mov_b32 v163, 0
    v_mov_b32 v164, 0
    v_mov_b32 v165, 0
    v_mov_b32 v166, 0
    v_mov_b32 v167, 0
    v_mov_b32 v168, 0
    v_mov_b32 v169, 0
    v_mov_b32 v170, 0
    v_mov_b32 v171, 0
    v_mov_b32 v172, 0
    v_mov_b32 v173, 0
    v_mov_b32 v174, 0
    v_mov_b32 v175, 0
    v_mov_b32 v80, 0
    v_mov_b32 v81, 0
    v_mov_b32 v82, 0
    v_mov_b32 v83, 0
    v_mov_b32 v84, 0
    v_mov_b32 v85, 0
    v_mov_b32 v86, 0
    v_mov_b32 v87, 0
    v_mov_b32 v88, 0
    v_mov_b32 v89, 0
    v_mov_b32 v90, 0
    v_mov_b32 v91, 0
    v_mov_b32 v92, 0
    v_mov_b32 v93, 0
    v_mov_b32 v94, 0
    v_mov_b32 v95, 0
    v_mov_b32 v176, 0
    v_mov_b32 v177, 0
    v_mov_b32 v178, 0
    v_mov_b32 v179, 0
    v_mov_b32 v180, 0
    v_mov_b32 v181, 0
    v_mov_b32 v182, 0
    v_mov_b32 v183, 0
    v_mov_b32 v184, 0
    v_mov_b32 v185, 0
    v_mov_b32 v186, 0
    v_mov_b32 v187, 0
    v_mov_b32 v188, 0
    v_mov_b32 v189, 0
    v_mov_b32 v190, 0
    v_mov_b32 v191, 0
    v_mov_b32 v208, 0
    v_mov_b32 v210, 0
    v_mov_b32 v209, 0
    v_mov_b32 v211, 0
    v_mov_b32 v220, 0x3f803f80
    v_mov_b32 v221, 0x3f803f80
    v_mov_b32 v222, 0x3f803f80
    v_mov_b32 v223, 0x3f803f80
    s_waitcnt vmcnt(8)
    s_barrier
    s_mov_b32 s36, 0
    s_mov_b32 s37, 0
    s_mov_b32 s38, 36864
    v_add_u32 v12, s37, v4
    v_add_u32 v13, s37, v8
    ds_read_b128 v[16:19], v12
    ds_read_b64_tr_b16 v[24:25], v13 offset:28672
    ds_read_b64_tr_b16 v[26:27], v13 offset:29184
    v_xor_b32 v48, 64, v13
    ds_read_b64_tr_b16 v[28:29], v48 offset:28672
    ds_read_b64_tr_b16 v[30:31], v48 offset:29184
    v_add_u32 v12, s37, v5
    v_add_u32 v53, s37, v9
    ds_read_b128 v[20:23], v12
    ds_read_b64_tr_b16 v[36:37], v53 offset:28672
    ds_read_b64_tr_b16 v[38:39], v53 offset:29184
    v_xor_b32 v48, 64, v53
    ds_read_b64_tr_b16 v[40:41], v48 offset:28672
    ds_read_b64_tr_b16 v[42:43], v48 offset:29184
L_p1_kernel_r1:
    s_waitcnt lgkmcnt(7)
    v_mfma_f32_32x32x16_bf16 v[64:79], v[24:27], v[16:19], v[64:79]
    v_add_u32 v12, s37, v6
    v_add_u32 v13, s37, v10
    ds_read_b128 v[224:227], v12
    ds_read_b64_tr_b16 v[232:233], v13 offset:28672
    ds_read_b64_tr_b16 v[234:235], v13 offset:29184
    v_lshlrev_b32 v212, 16, v18
    v_and_b32 v213, 0xffff0000, v18
    v_lshlrev_b32 v214, 16, v19
    v_and_b32 v215, 0xffff0000, v19
    v_add_f32 v208, v208, v212
    v_add_f32 v209, v209, v213
    s_waitcnt lgkmcnt(8)
    v_mfma_f32_32x32x16_bf16 v[80:95], v[28:31], v[16:19], v[80:95]
    v_xor_b32 v48, 64, v13
    ds_read_b64_tr_b16 v[236:237], v48 offset:28672
    ds_read_b64_tr_b16 v[238:239], v48 offset:29184
    v_fma_f32 v210, v212, v212, v210
    v_fma_f32 v211, v213, v213, v211
    v_add_f32 v208, v208, v214
    v_add_f32 v209, v209, v215
    v_fma_f32 v210, v214, v214, v210
    v_fma_f32 v211, v215, v215, v211
    v_mfma_f32_32x32x16_bf16 v[160:175], v[220:223], v[24:27], v[160:175]
    v_mfma_f32_32x32x16_bf16 v[176:191], v[220:223], v[28:31], v[176:191]
    s_waitcnt lgkmcnt(7)
    v_mfma_f32_32x32x16_bf16 v[64:79], v[36:39], v[20:23], v[64:79]
    v_add_u32 v12, s37, v7
    v_add_u32 v53, s37, v11
    ds_read_b128 v[228:231], v12
    ds_read_b64_tr_b16 v[244:245], v53 offset:28672
    ds_read_b64_tr_b16 v[246:247], v53 offset:29184
    v_lshlrev_b32 v212, 16, v22
    v_and_b32 v213, 0xffff0000, v22
    v_lshlrev_b32 v214, 16, v23
    v_and_b32 v215, 0xffff0000, v23
    v_add_f32 v208, v208, v212
    v_add_f32 v209, v209, v213
    s_waitcnt lgkmcnt(8)
    v_mfma_f32_32x32x16_bf16 v[80:95], v[40:43], v[20:23], v[80:95]
    v_xor_b32 v48, 64, v53
    ds_read_b64_tr_b16 v[248:249], v48 offset:28672
    ds_read_b64_tr_b16 v[250:251], v48 offset:29184
    v_fma_f32 v210, v212, v212, v210
    v_fma_f32 v211, v213, v213, v211
    v_add_f32 v208, v208, v214
    v_add_f32 v209, v209, v215
    v_fma_f32 v210, v214, v214, v210
    v_fma_f32 v211, v215, v215, v211
    s_waitcnt vmcnt(4)
    s_barrier
    s_add_u32 s29, s36, 3
    s_and_b32 s29, s29, 3
    s_mul_i32 s29, s29, 36864
    s_waitcnt lgkmcnt(7)
    v_mfma_f32_32x32x16_bf16 v[64:79], v[232:235], v[224:227], v[64:79]
    v_add_u32 v12, s38, v4
    v_add_u32 v13, s38, v8
    ds_read_b128 v[16:19], v12
    ds_read_b64_tr_b16 v[24:25], v13 offset:28672
    ds_read_b64_tr_b16 v[26:27], v13 offset:29184
    s_lshl_b32 s40, s26, 11
    s_add_u32 s40, s40, s29
    s_add_u32 m0, s40, 0
    s_nop 0
    buffer_load_dwordx4 v2, s[16:19], s39 offen lds
    v_lshlrev_b32 v212, 16, v226
    v_and_b32 v213, 0xffff0000, v226
    v_lshlrev_b32 v214, 16, v227
    v_and_b32 v215, 0xffff0000, v227
    v_add_f32 v208, v208, v212
    v_add_f32 v209, v209, v213
    s_waitcnt lgkmcnt(8)
    v_mfma_f32_32x32x16_bf16 v[80:95], v[236:239], v[224:227], v[80:95]
    v_xor_b32 v48, 64, v13
    ds_read_b64_tr_b16 v[28:29], v48 offset:28672
    ds_read_b64_tr_b16 v[30:31], v48 offset:29184
    s_add_u32 m0, s40, 1024
    s_nop 0
    buffer_load_dwordx4 v3, s[16:19], s39 offen lds
    s_add_u32 s39, s39, 128
    v_fma_f32 v210, v212, v212, v210
    v_fma_f32 v211, v213, v213, v211
    v_add_f32 v208, v208, v214
    v_add_f32 v209, v209, v215
    v_fma_f32 v210, v214, v214, v210
    v_fma_f32 v211, v215, v215, v211
    s_waitcnt lgkmcnt(7)
    v_mfma_f32_32x32x16_bf16 v[64:79], v[244:247], v[228:231], v[64:79]
    v_add_u32 v12, s38, v5
    v_add_u32 v53, s38, v9
    ds_read_b128 v[20:23], v12
    ds_read_b64_tr_b16 v[36:37], v53 offset:28672
    ds_read_b64_tr_b16 v[38:39], v53 offset:29184
    s_lshl_b32 s40, s27, 11
    s_add_u32 s40, s40, s29
    s_add_u32 m0, s40, 28672
    s_nop 0
    global_load_lds_dwordx4 v[54:55], off
    v_add_co_u32 v54, vcc, s41, v54
    v_addc_co_u32 v55, vcc, 0, v55, vcc
    v_lshlrev_b32 v212, 16, v230
    v_and_b32 v213, 0xffff0000, v230
    v_lshlrev_b32 v214, 16, v231
    v_and_b32 v215, 0xffff0000, v231
    v_add_f32 v208, v208, v212
    v_add_f32 v209, v209, v213
    s_waitcnt lgkmcnt(8)
    v_mfma_f32_32x32x16_bf16 v[80:95], v[248:251], v[228:231], v[80:95]
    v_xor_b32 v48, 64, v53
    ds_read_b64_tr_b16 v[40:41], v48 offset:28672
    ds_read_b64_tr_b16 v[42:43], v48 offset:29184
    s_add_u32 m0, s40, 29696
    s_nop 0
    global_load_lds_dwordx4 v[56:57], off
    v_add_co_u32 v56, vcc, s42, v56
    v_addc_co_u32 v57, vcc, 0, v57, vcc
    v_fma_f32 v210, v212, v212, v210
    v_fma_f32 v211, v213, v213, v211
    v_add_f32 v208, v208, v214
    v_add_f32 v209, v209, v215
    v_fma_f32 v210, v214, v214, v210
    v_fma_f32 v211, v215, v215, v211
    s_add_u32 s36, s36, 1
    s_mov_b32 s37, s38
    s_add_u32 s29, s36, 1
    s_and_b32 s29, s29, 3
    s_mul_i32 s38, s29, 36864
    s_cmp_lt_u32 s36, 5
    s_cbranch_scc1 L_p1_kernel_r1
L_p1_kernel_r1_b:
    s_waitcnt lgkmcnt(7)
    v_mfma_f32_32x32x16_bf16 v[64:79], v[24:27], v[16:19], v[64:79]
    v_add_u32 v12, s37, v6
    v_add_u32 v13, s37, v10
    ds_read_b128 v[224:227], v12
    ds_read_b64_tr_b16 v[232:233], v13 offset:28672
    ds_read_b64_tr_b16 v[234:235], v13 offset:29184
    v_lshlrev_b32 v212, 16, v18
    v_and_b32 v213, 0xffff0000, v18
    v_lshlrev_b32 v214, 16, v19
    v_and_b32 v215, 0xffff0000, v19
    v_add_f32 v208, v208, v212
    v_add_f32 v209, v209, v213
    s_waitcnt lgkmcnt(8)
    v_mfma_f32_32x32x16_bf16 v[80:95], v[28:31], v[16:19], v[80:95]
    v_xor_b32 v48, 64, v13
    ds_read_b64_tr_b16 v[236:237], v48 offset:28672
    ds_read_b64_tr_b16 v[238:239], v48 offset:29184
    v_fma_f32 v210, v212, v212, v210
    v_fma_f32 v211, v213, v213, v211
    v_add_f32 v208, v208, v214
    v_add_f32 v209, v209, v215
    v_fma_f32 v210, v214, v214, v210
    v_fma_f32 v211, v215, v215, v211
    v_mfma_f32_32x32x16_bf16 v[160:175], v[220:223], v[24:27], v[160:175]
    v_mfma_f32_32x32x16_bf16 v[176:191], v[220:223], v[28:31], v[176:191]
    s_waitcnt lgkmcnt(7)
    v_mfma_f32_32x32x16_bf16 v[64:79], v[36:39], v[20:23], v[64:79]
    v_add_u32 v12, s37, v7
    v_add_u32 v53, s37, v11
    ds_read_b128 v[228:231], v12
    ds_read_b64_tr_b16 v[244:245], v53 offset:28672
    ds_read_b64_tr_b16 v[246:247], v53 offset:29184
    v_lshlrev_b32 v212, 16, v22
    v_and_b32 v213, 0xffff0000, v22
    v_lshlrev_b32 v214, 16, v23
    v_and_b32 v215, 0xffff0000, v23
    v_add_f32 v208, v208, v212
    v_add_f32 v209, v209, v213
    s_waitcnt lgkmcnt(8)
    v_mfma_f32_32x32x16_bf16 v[80:95], v[40:43], v[20:23], v[80:95]
    v_xor_b32 v48, 64, v53
    ds_read_b64_tr_b16 v[248:249], v48 offset:28672
    ds_read_b64_tr_b16 v[250:251], v48 offset:29184
    v_fma_f32 v210, v212, v212, v210
    v_fma_f32 v211, v213, v213, v211
    v_add_f32 v208, v208, v214
    v_add_f32 v209, v209, v215
    v_fma_f32 v210, v214, v214, v210
    v_fma_f32 v211, v215, v215, v211
    s_cmp_eq_u32 s36, 7
    s_cbranch_scc1 L_p1_kernel_r1_b_nob
    s_cmp_eq_u32 s36, 6
    s_cbranch_scc1 L_p1_kernel_r1_b_w0
    s_waitcnt vmcnt(4)
    s_branch L_p1_kernel_r1_b_bar
L_p1_kernel_r1_b_w0:
    s_waitcnt vmcnt(0)
L_p1_kernel_r1_b_bar:
    s_barrier
L_p1_kernel_r1_b_nob:
    s_waitcnt lgkmcnt(7)
    v_mfma_f32_32x32x16_bf16 v[64:79], v[232:235], v[224:227], v[64:79]
    v_add_u32 v12, s38, v4
    v_add_u32 v13, s38, v8
    ds_read_b128 v[16:19], v12
    ds_read_b64_tr_b16 v[24:25], v13 offset:28672
    ds_read_b64_tr_b16 v[26:27], v13 offset:29184
    v_lshlrev_b32 v212, 16, v226
    v_and_b32 v213, 0xffff0000, v226
    v_lshlrev_b32 v214, 16, v227
    v_and_b32 v215, 0xffff0000, v227
    v_add_f32 v208, v208, v212
    v_add_f32 v209, v209, v213
    s_waitcnt lgkmcnt(8)
    v_mfma_f32_32x32x16_bf16 v[80:95], v[236:239], v[224:227], v[80:95]
    v_xor_b32 v48, 64, v13
    ds_read_b64_tr_b16 v[28:29], v48 offset:28672
    ds_read_b64_tr_b16 v[30:31], v48 offset:29184
    v_fma_f32 v210, v212, v212, v210
    v_fma_f32 v211, v213, v213, v211
    v_add_f32 v208, v208, v214
    v_add_f32 v209, v209, v215
    v_fma_f32 v210, v214, v214, v210
    v_fma_f32 v211, v215, v215, v211
    s_waitcnt lgkmcnt(7)
    v_mfma_f32_32x32x16_bf16 v[64:79], v[244:247], v[228:231], v[64:79]
    v_add_u32 v12, s38, v5
    v_add_u32 v53, s38, v9
    ds_read_b128 v[20:23], v12
    ds_read_b64_tr_b16 v[36:37], v53 offset:28672
    ds_read_b64_tr_b16 v[38:39], v53 offset:29184
    v_lshlrev_b32 v212, 16, v230
    v_and_b32 v213, 0xffff0000, v230
    v_lshlrev_b32 v214, 16, v231
    v_and_b32 v215, 0xffff0000, v231
    v_add_f32 v208, v208, v212
    v_add_f32 v209, v209, v213
    s_waitcnt lgkmcnt(8)
    v_mfma_f32_32x32x16_bf16 v[80:95], v[248:251], v[228:231], v[80:95]
    v_xor_b32 v48, 64, v53
    ds_read_b64_tr_b16 v[40:41], v48 offset:28672
    ds_read_b64_tr_b16 v[42:43], v48 offset:29184
    v_fma_f32 v210, v212, v212, v210
    v_fma_f32 v211, v213, v213, v211
    v_add_f32 v208, v208, v214
    v_add_f32 v209, v209, v215
    v_fma_f32 v210, v214, v214, v210
    v_fma_f32 v211, v215, v215, v211
    s_add_u32 s36, s36, 1
    s_mov_b32 s37, s38
    s_add_u32 s29, s36, 1
    s_and_b32 s29, s29, 3
    s_mul_i32 s38, s29, 36864
    s_cmp_lt_u32 s36, 8
    s_cbranch_scc1 L_p1_kernel_r1_b
    s_waitcnt lgkmcnt(0)
    v_add_f32 v51, v208, v209
    v_add_f32 v52, v210, v211
    v_mov_b32 v14, v51
    v_mov_b32 v15, v52
    s_nop 0
    v_permlane32_swap_b32 v14, v51
    v_permlane32_swap_b32 v15, v52
    s_nop 0
    v_add_f32 v62, v51, v14
    v_add_f32 v63, v52, v15
    v_and_b32 v14, 31, v1
    s_lshl_b32 s29, s27, 5
    v_add_u32 v15, s29, v14
    v_lshlrev_b32 v15, 3, v15
    v_add_u32 v15, 147456, v15
    ds_write_b64 v15, v[62:63] offset:1024
    v_lshlrev_b32 v14, 4, v14
    v_add_u32 v14, 151040, v14
    s_lshl_b32 s29, s27, 2
    v_add_u32 v12, s29, v14
    ds_write_b32 v12, v160 offset:0
    ds_write_b32 v12, v176 offset:512
    s_waitcnt lgkmcnt(0)
    s_barrier
    ds_read_b64 v[62:63], v15
    ds_read_b64 v[52:53], v15 offset:1024
    ds_read_b128 v[16:19], v14 offset:0
    ds_read_b128 v[20:23], v14 offset:512
    v_cmp_gt_u32 vcc, 32, v1
    v_mov_b32 v30, 0
    v_mov_b32 v31, 0
    v_mov_b32 v34, 0
    v_mov_b32 v35, 0
    v_mov_b32 v38, 0
    v_mov_b32 v39, 0
    s_waitcnt lgkmcnt(2)
    v_add_f32 v62, v62, v52
    v_add_f32 v63, v63, v53
    v_mul_f32 v62, 0xbb000000, v62
    v_mul_f32 v63, 0x3b000000, v63
    v_cvt_pk_bf16_f32 v28, v62, v62
    v_fma_f32 v63, -v62, v62, v63
    v_and_b32 v15, 0xffff0000, v28
    v_max_f32 v63, 0, v63
    v_sub_f32 v15, v62, v15
    v_add_f32 v63, 0x3727c5ac, v63
    v_cvt_pk_bf16_f32 v29, v15, 0
    v_rsq_f32 v60, v63
    v_cndmask_b32 v28, 0, v28, vcc
    v_cndmask_b32 v29, 0, v29, vcc
    s_waitcnt lgkmcnt(0)
    v_add_f32 v16, v16, v17
    v_add_f32 v18, v18, v19
    v_add_f32 v20, v20, v21
    v_add_f32 v22, v22, v23
    v_add_f32 v16, v16, v18
    v_add_f32 v20, v20, v22
    v_cvt_pk_bf16_f32 v33, v16, 0
    v_cvt_pk_bf16_f32 v37, v20, 0
    v_lshlrev_b32 v17, 16, v33
    v_lshlrev_b32 v21, 16, v37
    v_sub_f32 v17, v16, v17
    v_sub_f32 v21, v20, v21
    v_cvt_pk_bf16_f32 v32, v16, v17
    v_cvt_pk_bf16_f32 v36, v20, v21
    v_cndmask_b32 v32, 0, v32, vcc
    v_cndmask_b32 v33, 0, v33, vcc
    v_cndmask_b32 v36, 0, v36, vcc
    v_cndmask_b32 v37, 0, v37, vcc
    s_nop 1
    v_mfma_f32_32x32x16_bf16 v[64:79], v[32:35], v[28:31], v[64:79]
    v_mfma_f32_32x32x16_bf16 v[80:95], v[36:39], v[28:31], v[80:95]
    v_mul_f32 v44, 0xc0135761, v60
    v_mul_f32 v46, v60, v60
    v_mul_f32 v48, v63, v60
    v_mul_f32 v46, v46, v60
    v_mul_f32 v46, 0xbdd2d3e8, v46
    s_nop 9
    s_cmp_lt_u32 s25, 14
    s_cbranch_scc0 L_p1_kernel_noz2
    v_mov_b32 v208, 0
    v_mov_b32 v209, 0
    v_mov_b32 v210, 0
    v_mov_b32 v211, 0
    v_and_b32 v4, 31, v1
    v_mul_u32_u24 v4, 72, v4
    v_lshrrev_b32 v15, 5, v1
    v_lshlrev_b32 v15, 3, v15
    v_add_u32 v4, v4, v15
    s_mul_i32 s31, s26, 4608
    v_add_u32 v4, s31, v4
    v_lshrrev_b32 v5, 5, v1
    v_lshlrev_b32 v5, 3, v5
    v_bfe_u32 v15, v1, 2, 2
    v_add_u32 v5, v5, v15
    v_mul_u32_u24 v5, 72, v5
    v_bfe_u32 v15, v1, 4, 1
    v_lshlrev_b32 v15, 5, v15
    v_add_u32 v5, v5, v15
    v_and_b32 v15, 3, v1
    v_lshlrev_b32 v15, 3, v15
    v_add_u32 v5, v5, v15
    v_add_u32 v5, s31, v5
    v_pk_mul_f32 v[112:113], v[64:65], v[64:65]
    v_pk_mul_f32 v[114:115], v[66:67], v[66:67]
    v_pk_mul_f32 v[116:117], v[68:69], v[68:69]
    v_pk_mul_f32 v[118:119], v[70:71], v[70:71]
    v_pk_mul_f32 v[120:121], v[72:73], v[72:73]
    v_pk_mul_f32 v[122:123], v[74:75], v[74:75]
    v_pk_mul_f32 v[124:125], v[76:77], v[76:77]
    v_pk_mul_f32 v[126:127], v[78:79], v[78:79]
    v_pk_fma_f32 v[112:113], v[112:113], v[46:47], v[44:45] op_sel_hi:[1,0,0]
    v_pk_fma_f32 v[114:115], v[114:115], v[46:47], v[44:45] op_sel_hi:[1,0,0]
    v_pk_fma_f32 v[116:117], v[116:117], v[46:47], v[44:45] op_sel_hi:[1,0,0]
    v_pk_fma_f32 v[118:119], v[118:119], v[46:47], v[44:45] op_sel_hi:[1,0,0]
    v_pk_fma_f32 v[120:121], v[120:121], v[46:47], v[44:45] op_sel_hi:[1,0,0]
    v_pk_fma_f32 v[122:123], v[122:123], v[46:47], v[44:45] op_sel_hi:[1,0,0]
    v_pk_fma_f32 v[124:125], v[124:125], v[46:47], v[44:45] op_sel_hi:[1,0,0]
    v_pk_fma_f32 v[126:127], v[126:127], v[46:47], v[44:45] op_sel_hi:[1,0,0]
    v_pk_mul_f32 v[112:113], v[112:113], v[64:65]
    v_pk_mul_f32 v[114:115], v[114:115], v[66:67]
    v_pk_mul_f32 v[116:117], v[116:117], v[68:69]
    v_pk_mul_f32 v[118:119], v[118:119], v[70:71]
    v_pk_mul_f32 v[120:121], v[120:121], v[72:73]
    v_pk_mul_f32 v[122:123], v[122:123], v[74:75]
    v_pk_mul_f32 v[124:125], v[124:125], v[76:77]
    v_pk_mul_f32 v[126:127], v[126:127], v[78:79]
    v_exp_f32 v112, v112
    v_exp_f32 v113, v113
    v_exp_f32 v114, v114
    v_exp_f32 v115, v115
    v_exp_f32 v116, v116
    v_exp_f32 v117, v117
    v_exp_f32 v118, v118
    v_exp_f32 v119, v119
    v_exp_f32 v120, v120
    v_exp_f32 v121, v121
    v_exp_f32 v122, v122
    v_exp_f32 v123, v123
    v_exp_f32 v124, v124
    v_exp_f32 v125, v125
    v_exp_f32 v126, v126
    v_exp_f32 v127, v127
    v_pk_fma_f32 v[112:113], v[112:113], v[48:49], v[48:49] op_sel_hi:[1,0,0]
    v_pk_fma_f32 v[114:115], v[114:115], v[48:49], v[48:49] op_sel_hi:[1,0,0]
    v_pk_fma_f32 v[116:117], v[116:117], v[48:49], v[48:49] op_sel_hi:[1,0,0]
    v_pk_fma_f32 v[118:119], v[118:119], v[48:49], v[48:49] op_sel_hi:[1,0,0]
    v_pk_fma_f32 v[120:121], v[120:121], v[48:49], v[48:49] op_sel_hi:[1,0,0]
    v_pk_fma_f32 v[122:123], v[122:123], v[48:49], v[48:49] op_sel_hi:[1,0,0]
    v_pk_fma_f32 v[124:125], v[124:125], v[48:49], v[48:49] op_sel_hi:[1,0,0]
    v_pk_fma_f32 v[126:127], v[126:127], v[48:49], v[48:49] op_sel_hi:[1,0,0]
    v_rcp_f32 v112, v112
    v_rcp_f32 v113, v113
    v_rcp_f32 v114, v114
    v_rcp_f32 v115, v115
    v_rcp_f32 v116, v116
    v_rcp_f32 v117, v117
    v_rcp_f32 v118, v118
    v_rcp_f32 v119, v119
    v_rcp_f32 v120, v120
    v_rcp_f32 v121, v121
    v_rcp_f32 v122, v122
    v_rcp_f32 v123, v123
    v_rcp_f32 v124, v124
    v_rcp_f32 v125, v125
    v_rcp_f32 v126, v126
    v_rcp_f32 v127, v127
    v_pk_mul_f32 v[64:65], v[64:65], v[112:113]
    v_pk_mul_f32 v[66:67], v[66:67], v[114:115]
    v_pk_mul_f32 v[68:69], v[68:69], v[116:117]
    v_pk_mul_f32 v[70:71], v[70:71], v[118:119]
    v_pk_mul_f32 v[72:73], v[72:73], v[120:121]
    v_pk_mul_f32 v[74:75], v[74:75], v[122:123]
    v_pk_mul_f32 v[76:77], v[76:77], v[124:125]
    v_pk_mul_f32 v[78:79], v[78:79], v[126:127]
    v_pk_add_f32 v[208:209], v[208:209], v[64:65]
    v_pk_fma_f32 v[210:211], v[64:65], v[64:65], v[210:211]
    v_pk_add_f32 v[208:209], v[208:209], v[66:67]
    v_pk_fma_f32 v[210:211], v[66:67], v[66:67], v[210:211]
    v_pk_add_f32 v[208:209], v[208:209], v[68:69]
    v_pk_fma_f32 v[210:211], v[68:69], v[68:69], v[210:211]
    v_pk_add_f32 v[208:209], v[208:209], v[70:71]
    v_pk_fma_f32 v[210:211], v[70:71], v[70:71], v[210:211]
    v_pk_add_f32 v[208:209], v[208:209], v[72:73]
    v_pk_fma_f32 v[210:211], v[72:73], v[72:73], v[210:211]
    v_pk_add_f32 v[208:209], v[208:209], v[74:75]
    v_pk_fma_f32 v[210:211], v[74:75], v[74:75], v[210:211]
    v_pk_add_f32 v[208:209], v[208:209], v[76:77]
    v_pk_fma_f32 v[210:211], v[76:77], v[76:77], v[210:211]
    v_pk_add_f32 v[208:209], v[208:209], v[78:79]
    v_pk_fma_f32 v[210:211], v[78:79], v[78:79], v[210:211]
    v_cvt_pk_bf16_f32 v144, v64, v65
    v_cvt_pk_bf16_f32 v145, v66, v67
    v_cvt_pk_bf16_f32 v146, v68, v69
    v_cvt_pk_bf16_f32 v147, v70, v71
    v_cvt_pk_bf16_f32 v148, v72, v73
    v_cvt_pk_bf16_f32 v149, v74, v75
    v_cvt_pk_bf16_f32 v150, v76, v77
    v_cvt_pk_bf16_f32 v151, v78, v79
    ds_write_b64 v4, v[144:145] offset:0
    ds_write_b64 v4, v[146:147] offset:16
    ds_write_b64 v4, v[148:149] offset:32
    ds_write_b64 v4, v[150:151] offset:48
    s_waitcnt lgkmcnt(0)
    v_pk_mul_f32 v[112:113], v[80:81], v[80:81]
    v_pk_mul_f32 v[114:115], v[82:83], v[82:83]
    v_pk_mul_f32 v[116:117], v[84:85], v[84:85]
    v_pk_mul_f32 v[118:119], v[86:87], v[86:87]
    v_pk_mul_f32 v[120:121], v[88:89], v[88:89]
    v_pk_mul_f32 v[122:123], v[90:91], v[90:91]
    v_pk_mul_f32 v[124:125], v[92:93], v[92:93]
    v_pk_mul_f32 v[126:127], v[94:95], v[94:95]
    v_pk_fma_f32 v[112:113], v[112:113], v[46:47], v[44:45] op_sel_hi:[1,0,0]
    v_pk_fma_f32 v[114:115], v[114:115], v[46:47], v[44:45] op_sel_hi:[1,0,0]
    v_pk_fma_f32 v[116:117], v[116:117], v[46:47], v[44:45] op_sel_hi:[1,0,0]
    v_pk_fma_f32 v[118:119], v[118:119], v[46:47], v[44:45] op_sel_hi:[1,0,0]
    v_pk_fma_f32 v[120:121], v[120:121], v[46:47], v[44:45] op_sel_hi:[1,0,0]
    v_pk_fma_f32 v[122:123], v[122:123], v[46:47], v[44:45] op_sel_hi:[1,0,0]
    v_pk_fma_f32 v[124:125], v[124:125], v[46:47], v[44:45] op_sel_hi:[1,0,0]
    v_pk_fma_f32 v[126:127], v[126:127], v[46:47], v[44:45] op_sel_hi:[1,0,0]
    v_pk_mul_f32 v[112:113], v[112:113], v[80:81]
    v_pk_mul_f32 v[114:115], v[114:115], v[82:83]
    v_pk_mul_f32 v[116:117], v[116:117], v[84:85]
    v_pk_mul_f32 v[118:119], v[118:119], v[86:87]
    v_pk_mul_f32 v[120:121], v[120:121], v[88:89]
    v_pk_mul_f32 v[122:123], v[122:123], v[90:91]
    v_pk_mul_f32 v[124:125], v[124:125], v[92:93]
    v_pk_mul_f32 v[126:127], v[126:127], v[94:95]
    v_exp_f32 v112, v112
    v_exp_f32 v113, v113
    v_exp_f32 v114, v114
    v_exp_f32 v115, v115
    v_exp_f32 v116, v116
    v_exp_f32 v117, v117
    v_exp_f32 v118, v118
    v_exp_f32 v119, v119
    v_exp_f32 v120, v120
    v_exp_f32 v121, v121
    v_exp_f32 v122, v122
    v_exp_f32 v123, v123
    v_exp_f32 v124, v124
    v_exp_f32 v125, v125
    v_exp_f32 v126, v126
    v_exp_f32 v127, v127
    v_pk_fma_f32 v[112:113], v[112:113], v[48:49], v[48:49] op_sel_hi:[1,0,0]
    v_pk_fma_f32 v[114:115], v[114:115], v[48:49], v[48:49] op_sel_hi:[1,0,0]
    v_pk_fma_f32 v[116:117], v[116:117], v[48:49], v[48:49] op_sel_hi:[1,0,0]
    v_pk_fma_f32 v[118:119], v[118:119], v[48:49], v[48:49] op_sel_hi:[1,0,0]
    v_pk_fma_f32 v[120:121], v[120:121], v[48:49], v[48:49] op_sel_hi:[1,0,0]
    v_pk_fma_f32 v[122:123], v[122:123], v[48:49], v[48:49] op_sel_hi:[1,0,0]
    v_pk_fma_f32 v[124:125], v[124:125], v[48:49], v[48:49] op_sel_hi:[1,0,0]
    v_pk_fma_f32 v[126:127], v[126:127], v[48:49], v[48:49] op_sel_hi:[1,0,0]
    v_rcp_f32 v112, v112
    v_rcp_f32 v113, v113
    v_rcp_f32 v114, v114
    v_rcp_f32 v115, v115
    v_rcp_f32 v116, v116
    v_rcp_f32 v117, v117
    v_rcp_f32 v118, v118
    v_rcp_f32 v119, v119
    v_rcp_f32 v120, v120
    v_rcp_f32 v121, v121
    v_rcp_f32 v122, v122
    v_rcp_f32 v123, v123
    v_rcp_f32 v124, v124
    v_rcp_f32 v125, v125
    v_rcp_f32 v126, v126
    v_rcp_f32 v127, v127
    v_pk_mul_f32 v[80:81], v[80:81], v[112:113]
    v_pk_mul_f32 v[82:83], v[82:83], v[114:115]
    v_pk_mul_f32 v[84:85], v[84:85], v[116:117]
    v_pk_mul_f32 v[86:87], v[86:87], v[118:119]
    v_pk_mul_f32 v[88:89], v[88:89], v[120:121]
    v_pk_mul_f32 v[90:91], v[90:91], v[122:123]
    v_pk_mul_f32 v[92:93], v[92:93], v[124:125]
    v_pk_mul_f32 v[94:95], v[94:95], v[126:127]
    v_pk_add_f32 v[208:209], v[208:209], v[80:81]
    v_pk_fma_f32 v[210:211], v[80:81], v[80:81], v[210:211]
    v_pk_add_f32 v[208:209], v[208:209], v[82:83]
    v_pk_fma_f32 v[210:211], v[82:83], v[82:83], v[210:211]
    v_pk_add_f32 v[208:209], v[208:209], v[84:85]
    v_pk_fma_f32 v[210:211], v[84:85], v[84:85], v[210:211]
    v_pk_add_f32 v[208:209], v[208:209], v[86:87]
    v_pk_fma_f32 v[210:211], v[86:87], v[86:87], v[210:211]
    v_pk_add_f32 v[208:209], v[208:209], v[88:89]
    v_pk_fma_f32 v[210:211], v[88:89], v[88:89], v[210:211]
    v_pk_add_f32 v[208:209], v[208:209], v[90:91]
    v_pk_fma_f32 v[210:211], v[90:91], v[90:91], v[210:211]
    v_pk_add_f32 v[208:209], v[208:209], v[92:93]
    v_pk_fma_f32 v[210:211], v[92:93], v[92:93], v[210:211]
    v_pk_add_f32 v[208:209], v[208:209], v[94:95]
    v_pk_fma_f32 v[210:211], v[94:95], v[94:95], v[210:211]
    v_cvt_pk_bf16_f32 v144, v80, v81
    v_cvt_pk_bf16_f32 v145, v82, v83
    v_cvt_pk_bf16_f32 v146, v84, v85
    v_cvt_pk_bf16_f32 v147, v86, v87
    v_cvt_pk_bf16_f32 v148, v88, v89
    v_cvt_pk_bf16_f32 v149, v90, v91
    v_cvt_pk_bf16_f32 v150, v92, v93
    v_cvt_pk_bf16_f32 v151, v94, v95
    ds_write_b64 v4, v[144:145] offset:2304
    ds_write_b64 v4, v[146:147] offset:2320
    ds_write_b64 v4, v[148:149] offset:2336
    ds_write_b64 v4, v[150:151] offset:2352
    s_waitcnt lgkmcnt(0)
    ds_read_b64_tr_b16 v[152:153], v5 offset:0
    ds_read_b64_tr_b16 v[154:155], v5 offset:288
    ds_read_b64_tr_b16 v[156:157], v5 offset:1152
    ds_read_b64_tr_b16 v[158:159], v5 offset:1440
    ds_read_b64_tr_b16 v[16:17], v5 offset:2304
    ds_read_b64_tr_b16 v[18:19], v5 offset:2592
    ds_read_b64_tr_b16 v[20:21], v5 offset:3456
    ds_read_b64_tr_b16 v[22:23], v5 offset:3744
    v_lshlrev_b32 v140, 4, v1
    s_lshl_b32 s29, s46, 1
    s_mul_i32 s29, s29, 28
    s_lshl_b32 s30, s25, 1
    s_add_u32 s29, s29, s30
    s_add_u32 s29, s29, 0
    s_lshl_b32 s29, s29, 10
    s_add_u32 s29, s29, 6291456
    s_add_u32 s30, s29, 28672
    s_waitcnt lgkmcnt(4)
    buffer_store_dwordx4 v[152:155], v140, s[20:23], s29 offen sc1
    buffer_store_dwordx4 v[156:159], v140, s[20:23], s30 offen sc1
    s_lshl_b32 s29, s46, 1
    s_mul_i32 s29, s29, 28
    s_lshl_b32 s30, s25, 1
    s_add_u32 s29, s29, s30
    s_add_u32 s29, s29, 1
    s_lshl_b32 s29, s29, 10
    s_add_u32 s29, s29, 6291456
    s_add_u32 s30, s29, 28672
    s_waitcnt lgkmcnt(0)
    buffer_store_dwordx4 v[16:19], v140, s[20:23], s29 offen sc1
    buffer_store_dwordx4 v[20:23], v140, s[20:23], s30 offen sc1
    v_add_f32 v51, v208, v209
    v_add_f32 v52, v210, v211
    s_branch L_p1_kernel_st
L_p1_kernel_noz2:
    v_mov_b32 v51, 0
    v_mov_b32 v52, 0
    s_mov_b32 s30, s24
    s_cmp_eq_u32 s25, 15
    s_cbranch_scc1 L_p1_kernel_zf
    s_cmp_eq_u32 s24, 0
    s_cbranch_scc0 L_p1_kernel_st
    s_mov_b32 s30, 16
L_p1_kernel_zf:
    v_mov_b32 v144, 0
    v_mov_b32 v145, 0
    v_mov_b32 v146, 0
    v_mov_b32 v147, 0
    s_lshl_b32 s29, s30, 2
    s_add_u32 s29, s29, s27
    s_lshl_b32 s29, s29, 10
    s_add_u32 s29, s29, 2232320
    v_lshlrev_b32 v140, 4, v1
    buffer_store_dwordx4 v[144:147], v140, s[20:23], s29 offen sc1
L_p1_kernel_st:
    v_mov_b32 v15, v51
    s_nop 1
    v_permlane32_swap_b32 v15, v51
    s_nop 1
    v_add_f32 v51, v51, v15
    v_mov_b32 v15, v52
    s_nop 1
    v_permlane32_swap_b32 v15, v52
    s_nop 1
    v_add_f32 v52, v52, v15
    v_mov_b32 v144, v51
    v_mov_b32 v145, v52
    s_lshl_b32 s29, s46, 4
    s_add_u32 s29, s29, s25
    s_lshl_b32 s29, s29, 8
    s_add_u32 s29, s29, 2359296
    v_and_b32 v140, 31, v1
    v_lshlrev_b32 v140, 3, v140
    buffer_store_dwordx2 v[144:145], v140, s[20:23], s29 offen sc1
    s_branch L_p1_kernel_done
L_p1_kernel_done:
    s_waitcnt vmcnt(0)
L_p1_kernel_end:
    s_endpgm

.section .rodata,"a"
.p2align 6
.amdhsa_kernel p1_kernel
  .amdhsa_next_free_vgpr 256
  .amdhsa_next_free_sgpr 100
  .amdhsa_accum_offset 256
  .amdhsa_group_segment_fixed_size 0
  .amdhsa_kernarg_size 104
  .amdhsa_user_sgpr_count 2
  .amdhsa_user_sgpr_kernarg_segment_ptr 1
  .amdhsa_system_sgpr_workgroup_id_x 1
  .amdhsa_float_denorm_mode_32 3
  .amdhsa_float_denorm_mode_16_64 3
.end_amdhsa_kernel
.text
.globl p23_kernel
.p2align 8
.type p23_kernel,@function
p23_kernel:
    s_cmp_ge_u32 s2, 256
    s_cbranch_scc1 L_p23_kernel_end
    s_load_dwordx2 s[4:5], s[0:1], 96
    s_load_dwordx4 s[8:11], s[0:1], 56
    s_load_dwordx2 s[48:49], s[0:1], 0
    s_load_dwordx2 s[52:53], s[0:1], 80
    s_load_dwordx2 s[56:57], s[0:1], 32
    s_load_dwordx2 s[60:61], s[0:1], 72
    v_and_b32 v1, 63, v0
    v_lshrrev_b32 v2, 6, v0
    s_nop 0
    v_readfirstlane_b32 s26, v2
    s_and_b32 s28, s2, 7
    s_lshr_b32 s29, s2, 3
    s_and_b32 s25, s29, 7
    s_lshr_b32 s24, s29, 3
    s_lshl_b32 s24, s24, 3
    s_add_u32 s24, s24, s28
    s_and_b32 s27, s26, 3
    s_mov_b32 s40, 0x0000ffff
    s_mov_b32 s41, 0x0000ffff
    s_waitcnt lgkmcnt(0)
    s_mov_b32 s12, s4
    s_mov_b32 s13, s5
    s_mov_b32 s14, 19398656
    s_mov_b32 s15, 0x00020000
    s_mov_b32 s16, s8
    s_mov_b32 s17, s9
    s_mov_b32 s18, 8388608
    s_mov_b32 s19, 0x00020000
    s_mov_b32 s20, s10
    s_mov_b32 s21, s11
    s_mov_b32 s22, 4096
    s_mov_b32 s23, 0x00020000
    s_mov_b32 s50, 2097152
    s_mov_b32 s51, 0x00020000
    s_mov_b32 s54, 2097152
    s_mov_b32 s55, 0x00020000
    s_mov_b32 s58, 524288
    s_mov_b32 s59, 0x00020000
    s_mov_b32 s62, 917504
    s_mov_b32 s63, 0x00020000
    s_cmp_ge_u32 s26, 4
    s_cbranch_scc1 L_p23_kernel_B
    s_and_b32 s28, s27, 1
    s_lshl_b32 s37, s24, 1
    s_add_u32 s37, s37, s28
    v_lshlrev_b32 v2, 4, v1
    s_lshr_b32 s28, s27, 1
    s_lshl_b32 s28, s28, 16
    s_and_b32 s29, s27, 1
    s_lshl_b32 s29, s29, 13
    s_add_u32 s28, s28, s29
    s_add_u32 s29, s28, 2097152
    s_add_u32 m0, s28, 0
    s_add_u32 s30, s29, 0
    buffer_load_dwordx4 v2, s[12:15], s30 offen lds
    s_add_u32 m0, s28, 1024
    s_add_u32 s30, s29, 1024
    buffer_load_dwordx4 v2, s[12:15], s30 offen lds
    s_add_u32 m0, s28, 2048
    s_add_u32 s30, s29, 2048
    buffer_load_dwordx4 v2, s[12:15], s30 offen lds
    s_add_u32 m0, s28, 3072
    s_add_u32 s30, s29, 3072
    buffer_load_dwordx4 v2, s[12:15], s30 offen lds
    s_add_u32 m0, s28, 4096
    s_add_u32 s30, s29, 4096
    buffer_load_dwordx4 v2, s[12:15], s30 offen lds
    s_add_u32 m0, s28, 5120
    s_add_u32 s30, s29, 5120
    buffer_load_dwordx4 v2, s[12:15], s30 offen lds
    s_add_u32 m0, s28, 6144
    s_add_u32 s30, s29, 6144
    buffer_load_dwordx4 v2, s[12:15], s30 offen lds
    s_add_u32 m0, s28, 7168
    s_add_u32 s30, s29, 7168
    buffer_load_dwordx4 v2, s[12:15], s30 offen lds
    s_lshl_b32 s28, s37, 5
    s_lshl_b32 s29, s25, 2
    s_add_u32 s28, s28, s29
    s_and_b32 s29, s27, 2
    s_add_u32 s28, s28, s29
    s_lshl_b32 s28, s28, 10
    s_add_u32 s28, s28, 0
    v_lshlrev_b32 v2, 4, v1
    buffer_load_dwordx4 v[8:11], v2, s[12:15], s28 offen offset:0
    buffer_load_dwordx4 v[12:15], v2, s[12:15], s28 offen offset:1024
    v_lshlrev_b32 v3, 2, v1
    s_mov_b32 s28, 2228224
    buffer_load_dword v4, v3, s[12:15], s28 offen
    buffer_load_dword v5, v3, s[12:15], s28 offen offset:256
    v_mov_b32 v16, 0
    v_mov_b32 v17, 0
    v_mov_b32 v18, 0
    v_mov_b32 v19, 0
    v_mov_b32 v20, 0
    v_mov_b32 v21, 0
    v_mov_b32 v22, 0
    v_mov_b32 v23, 0
    v_mov_b32 v24, 0
    v_mov_b32 v25, 0
    v_mov_b32 v26, 0
    v_mov_b32 v27, 0
    v_mov_b32 v28, 0
    v_mov_b32 v29, 0
    v_mov_b32 v30, 0
    v_mov_b32 v31, 0
    v_mov_b32 v104, 0
    v_mov_b32 v32, 0
    v_mov_b32 v33, 0
    v_mov_b32 v34, 0
    v_mov_b32 v35, 0
    v_mov_b32 v36, 0
    v_mov_b32 v37, 0
    v_mov_b32 v38, 0
    v_mov_b32 v39, 0
    v_mov_b32 v40, 0
    v_mov_b32 v41, 0
    v_mov_b32 v42, 0
    v_mov_b32 v43, 0
    v_mov_b32 v44, 0
    v_mov_b32 v45, 0
    v_mov_b32 v46, 0
    v_mov_b32 v47, 0
    v_mov_b32 v105, 0
    v_mov_b32 v64, 0
    v_mov_b32 v65, 0
    v_mov_b32 v66, 0
    v_mov_b32 v67, 0
    v_mov_b32 v68, 0
    v_mov_b32 v69, 0
    v_mov_b32 v70, 0
    v_mov_b32 v71, 0
    v_mov_b32 v72, 0
    v_mov_b32 v73, 0
    v_mov_b32 v74, 0
    v_mov_b32 v75, 0
    v_mov_b32 v76, 0
    v_mov_b32 v77, 0
    v_mov_b32 v78, 0
    v_mov_b32 v79, 0
    v_and_b32 v6, 31, v1
    v_cmp_eq_u32 vcc, 16, v6
    v_mov_b32 v7, 0x3f803f80
    s_nop 0
    v_cndmask_b32 v88, 0, v7, vcc
    v_cndmask_b32 v89, 0, v7, vcc
    v_cndmask_b32 v90, 0, v7, vcc
    v_cndmask_b32 v91, 0, v7, vcc
    v_cndmask_b32 v92, 0, v7, vcc
    v_cndmask_b32 v93, 0, v7, vcc
    v_cndmask_b32 v94, 0, v7, vcc
    v_cndmask_b32 v95, 0, v7, vcc
    v_cndmask_b32 v96, 0, v7, vcc
    v_cndmask_b32 v97, 0, v7, vcc
    v_cndmask_b32 v98, 0, v7, vcc
    v_cndmask_b32 v99, 0, v7, vcc
    v_cndmask_b32 v100, 0, v7, vcc
    v_cndmask_b32 v101, 0, v7, vcc
    v_cndmask_b32 v102, 0, v7, vcc
    v_cndmask_b32 v103, 0, v7, vcc
    v_lshlrev_b32 v6, 4, v1
    v_and_b32 v7, 15, v1
    v_lshlrev_b32 v7, 4, v7
    v_lshrrev_b32 v2, 5, v1
    v_lshlrev_b32 v2, 8, v2
    v_add_u32 v7, v7, v2
    v_add_u32 v7, 65536, v7
    s_waitcnt vmcnt(0)
    v_mov_b32 v109, 0
    v_mov_b32 v110, 0
    s_nop 0
    v_dot2c_f32_bf16 v109, v8, v8
    v_dot2c_f32_bf16 v110, v12, v12
    v_dot2c_f32_bf16 v109, v9, v9
    v_dot2c_f32_bf16 v110, v13, v13
    v_dot2c_f32_bf16 v109, v10, v10
    v_dot2c_f32_bf16 v110, v14, v14
    v_dot2c_f32_bf16 v109, v11, v11
    v_dot2c_f32_bf16 v110, v15, v15
    s_nop 1
    v_mov_b32 v113, v109
    v_mov_b32 v114, v110
    s_nop 0
    v_permlane32_swap_b32 v113, v109
    v_permlane32_swap_b32 v114, v110
    s_nop 0
    v_add_f32 v109, v109, v113
    v_add_f32 v110, v110, v114
    v_max_f32 v2, v109, v110
    s_nop 0
    v_max_f32_dpp v4, v4, v4 row_ror:8 row_mask:0xf bank_mask:0xf
    v_max_f32_dpp v5, v5, v5 row_ror:8 row_mask:0xf bank_mask:0xf
    v_max_f32_dpp v2, v2, v2 row_ror:8 row_mask:0xf bank_mask:0xf
    v_max_f32_dpp v4, v4, v4 row_ror:4 row_mask:0xf bank_mask:0xf
    v_max_f32_dpp v5, v5, v5 row_ror:4 row_mask:0xf bank_mask:0xf
    v_max_f32_dpp v2, v2, v2 row_ror:4 row_mask:0xf bank_mask:0xf
    v_max_f32_dpp v4, v4, v4 row_ror:2 row_mask:0xf bank_mask:0xf
    v_max_f32_dpp v5, v5, v5 row_ror:2 row_mask:0xf bank_mask:0xf
    v_max_f32_dpp v2, v2, v2 row_ror:2 row_mask:0xf bank_mask:0xf
    v_max_f32_dpp v4, v4, v4 row_ror:1 row_mask:0xf bank_mask:0xf
    v_max_f32_dpp v5, v5, v5 row_ror:1 row_mask:0xf bank_mask:0xf
    v_max_f32_dpp v2, v2, v2 row_ror:1 row_mask:0xf bank_mask:0xf
    v_mov_b32 v113, v4
    v_mov_b32 v114, v5
    v_mov_b32 v115, v2
    v_permlane16_swap_b32 v113, v4
    v_permlane16_swap_b32 v114, v5
    v_permlane16_swap_b32 v115, v2
    s_nop 0
    v_max_f32 v4, v4, v113
    v_max_f32 v5, v5, v114
    v_max_f32 v2, v2, v115
    v_mov_b32 v113, v4
    v_mov_b32 v114, v5
    v_mov_b32 v115, v2
    v_permlane32_swap_b32 v113, v4
    v_permlane32_swap_b32 v114, v5
    v_permlane32_swap_b32 v115, v2
    s_nop 0
    v_max_f32 v4, v4, v113
    v_max_f32 v5, v5, v114
    v_max_f32 v2, v2, v115
    v_mul_f32 v2, v2, v4
    v_mov_b32 v108, 0x47000000
    v_cmp_ge_f32 vcc, 0x46192000, v2
    v_cmp_ge_f32 s[28:29], v108, v5
    s_nop 1
    s_and_b64 s[30:31], vcc, s[28:29]
    s_barrier
    s_cmp_eq_u64 s[30:31], exec
    s_cbranch_scc0 L_p23_kernel_slow
    ds_read_b128 v[80:83], v6 offset:0
    s_mov_b64 exec, s[40:41]
    ds_read_b128 v[88:91], v7 offset:0
    ds_read_b128 v[92:95], v7 offset:512
    s_mov_b64 exec, -1
    s_waitcnt lgkmcnt(0)
    v_mfma_f32_32x32x16_bf16 v[48:63], v[80:83], v[8:11], 0
    s_nop 11
    s_mov_b32 s36, 8
L_p23_kernel_Af:
    v_exp_f32 v48, v48
    v_exp_f32 v49, v49
    v_mfma_f32_32x32x16_bf16 v[32:47], v[100:103], v[68:71], v[32:47]
    v_exp_f32 v50, v50
    v_exp_f32 v51, v51
    v_exp_f32 v52, v52
    v_mfma_f32_32x32x16_bf16 v[64:79], v[80:83], v[12:15], 0
    ds_read_b128 v[84:87], v6 offset:1024
    s_mov_b64 exec, s[40:41]
    ds_read_b128 v[96:99], v7 offset:1024
    ds_read_b128 v[100:103], v7 offset:1536
    s_mov_b64 exec, -1
    v_exp_f32 v53, v53
    v_exp_f32 v54, v54
    v_exp_f32 v55, v55
    v_cvt_pk_bf16_f32 v48, v48, v49
    v_cvt_pk_bf16_f32 v49, v50, v51
    v_cvt_pk_bf16_f32 v50, v52, v53
    v_cvt_pk_bf16_f32 v51, v54, v55
    v_exp_f32 v56, v56
    v_exp_f32 v57, v57
    v_mfma_f32_32x32x16_bf16 v[16:31], v[88:91], v[48:51], v[16:31]
    v_exp_f32 v58, v58
    v_exp_f32 v59, v59
    v_exp_f32 v60, v60
    v_exp_f32 v61, v61
    v_exp_f32 v62, v62
    v_exp_f32 v63, v63
    v_cvt_pk_bf16_f32 v52, v56, v57
    v_cvt_pk_bf16_f32 v53, v58, v59
    v_cvt_pk_bf16_f32 v54, v60, v61
    v_cvt_pk_bf16_f32 v55, v62, v63
    v_exp_f32 v64, v64
    v_exp_f32 v65, v65
    v_mfma_f32_32x32x16_bf16 v[16:31], v[92:95], v[52:55], v[16:31]
    v_exp_f32 v66, v66
    v_exp_f32 v67, v67
    s_waitcnt lgkmcnt(0)
    v_exp_f32 v68, v68
    v_mfma_f32_32x32x16_bf16 v[48:63], v[84:87], v[8:11], 0
    v_exp_f32 v69, v69
    v_exp_f32 v70, v70
    v_exp_f32 v71, v71
    v_cvt_pk_bf16_f32 v64, v64, v65
    v_cvt_pk_bf16_f32 v65, v66, v67
    v_cvt_pk_bf16_f32 v66, v68, v69
    v_cvt_pk_bf16_f32 v67, v70, v71
    v_exp_f32 v72, v72
    v_exp_f32 v73, v73
    v_mfma_f32_32x32x16_bf16 v[32:47], v[88:91], v[64:67], v[32:47]
    v_exp_f32 v74, v74
    v_exp_f32 v75, v75
    v_exp_f32 v76, v76
    v_exp_f32 v77, v77
    v_exp_f32 v78, v78
    v_exp_f32 v79, v79
    v_cvt_pk_bf16_f32 v68, v72, v73
    v_cvt_pk_bf16_f32 v69, v74, v75
    v_cvt_pk_bf16_f32 v70, v76, v77
    v_cvt_pk_bf16_f32 v71, v78, v79
    v_exp_f32 v48, v48
    v_exp_f32 v49, v49
    v_mfma_f32_32x32x16_bf16 v[32:47], v[92:95], v[68:71], v[32:47]
    v_exp_f32 v50, v50
    v_exp_f32 v51, v51
    v_exp_f32 v52, v52
    v_mfma_f32_32x32x16_bf16 v[64:79], v[84:87], v[12:15], 0
    ds_read_b128 v[80:83], v6 offset:2048
    s_mov_b64 exec, s[40:41]
    ds_read_b128 v[88:91], v7 offset:2048
    ds_read_b128 v[92:95], v7 offset:2560
    s_mov_b64 exec, -1
    v_exp_f32 v53, v53
    v_exp_f32 v54, v54
    v_exp_f32 v55, v55
    v_cvt_pk_bf16_f32 v48, v48, v49
    v_cvt_pk_bf16_f32 v49, v50, v51
    v_cvt_pk_bf16_f32 v50, v52, v53
    v_cvt_pk_bf16_f32 v51, v54, v55
    v_exp_f32 v56, v56
    v_exp_f32 v57, v57
    v_mfma_f32_32x32x16_bf16 v[16:31], v[96:99], v[48:51], v[16:31]
    v_exp_f32 v58, v58
    v_exp_f32 v59, v59
    v_exp_f32 v60, v60
    v_exp_f32 v61, v61
    v_exp_f32 v62, v62
    v_exp_f32 v63, v63
    v_cvt_pk_bf16_f32 v52, v56, v57
    v_cvt_pk_bf16_f32 v53, v58, v59
    v_cvt_pk_bf16_f32 v54, v60, v61
    v_cvt_pk_bf16_f32 v55, v62, v63
    v_exp_f32 v64, v64
    v_exp_f32 v65, v65
    v_mfma_f32_32x32x16_bf16 v[16:31], v[100:103], v[52:55], v[16:31]
    v_exp_f32 v66, v66
    v_exp_f32 v67, v67
    s_waitcnt lgkmcnt(0)
    v_exp_f32 v68, v68
    v_mfma_f32_32x32x16_bf16 v[48:63], v[80:83], v[8:11], 0
    v_exp_f32 v69, v69
    v_exp_f32 v70, v70
    v_exp_f32 v71, v71
    v_cvt_pk_bf16_f32 v64, v64, v65
    v_cvt_pk_bf16_f32 v65, v66, v67
    v_cvt_pk_bf16_f32 v66, v68, v69
    v_cvt_pk_bf16_f32 v67, v70, v71
    v_exp_f32 v72, v72
    v_exp_f32 v73, v73
    v_mfma_f32_32x32x16_bf16 v[32:47], v[96:99], v[64:67], v[32:47]
    v_exp_f32 v74, v74
    v_exp_f32 v75, v75
    v_exp_f32 v76, v76
    v_exp_f32 v77, v77
    v_exp_f32 v78, v78
    v_exp_f32 v79, v79
    v_cvt_pk_bf16_f32 v68, v72, v73
    v_cvt_pk_bf16_f32 v69, v74, v75
    v_cvt_pk_bf16_f32 v70, v76, v77
    v_cvt_pk_bf16_f32 v71, v78, v79
    v_exp_f32 v48, v48
    v_exp_f32 v49, v49
    v_mfma_f32_32x32x16_bf16 v[32:47], v[100:103], v[68:71], v[32:47]
    v_exp_f32 v50, v50
    v_exp_f32 v51, v51
    v_exp_f32 v52, v52
    v_mfma_f32_32x32x16_bf16 v[64:79], v[80:83], v[12:15], 0
    ds_read_b128 v[84:87], v6 offset:3072
    s_mov_b64 exec, s[40:41]
    ds_read_b128 v[96:99], v7 offset:3072
    ds_read_b128 v[100:103], v7 offset:3584
    s_mov_b64 exec, -1
    v_exp_f32 v53, v53
    v_exp_f32 v54, v54
    v_exp_f32 v55, v55
    v_cvt_pk_bf16_f32 v48, v48, v49
    v_cvt_pk_bf16_f32 v49, v50, v51
    v_cvt_pk_bf16_f32 v50, v52, v53
    v_cvt_pk_bf16_f32 v51, v54, v55
    v_exp_f32 v56, v56
    v_exp_f32 v57, v57
    v_mfma_f32_32x32x16_bf16 v[16:31], v[88:91], v[48:51], v[16:31]
    v_exp_f32 v58, v58
    v_exp_f32 v59, v59
    v_exp_f32 v60, v60
    v_exp_f32 v61, v61
    v_exp_f32 v62, v62
    v_exp_f32 v63, v63
    v_cvt_pk_bf16_f32 v52, v56, v57
    v_cvt_pk_bf16_f32 v53, v58, v59
    v_cvt_pk_bf16_f32 v54, v60, v61
    v_cvt_pk_bf16_f32 v55, v62, v63
    v_exp_f32 v64, v64
    v_exp_f32 v65, v65
    v_mfma_f32_32x32x16_bf16 v[16:31], v[92:95], v[52:55], v[16:31]
    v_exp_f32 v66, v66
    v_exp_f32 v67, v67
    s_waitcnt lgkmcnt(0)
    v_exp_f32 v68, v68
    v_mfma_f32_32x32x16_bf16 v[48:63], v[84:87], v[8:11], 0
    v_exp_f32 v69, v69
    v_exp_f32 v70, v70
    v_exp_f32 v71, v71
    v_cvt_pk_bf16_f32 v64, v64, v65
    v_cvt_pk_bf16_f32 v65, v66, v67
    v_cvt_pk_bf16_f32 v66, v68, v69
    v_cvt_pk_bf16_f32 v67, v70, v71
    v_exp_f32 v72, v72
    v_exp_f32 v73, v73
    v_mfma_f32_32x32x16_bf16 v[32:47], v[88:91], v[64:67], v[32:47]
    v_exp_f32 v74, v74
    v_exp_f32 v75, v75
    v_exp_f32 v76, v76
    v_exp_f32 v77, v77
    v_exp_f32 v78, v78
    v_exp_f32 v79, v79
    v_cvt_pk_bf16_f32 v68, v72, v73
    v_cvt_pk_bf16_f32 v69, v74, v75
    v_cvt_pk_bf16_f32 v70, v76, v77
    v_cvt_pk_bf16_f32 v71, v78, v79
    v_exp_f32 v48, v48
    v_exp_f32 v49, v49
    v_mfma_f32_32x32x16_bf16 v[32:47], v[92:95], v[68:71], v[32:47]
    v_exp_f32 v50, v50
    v_exp_f32 v51, v51
    v_exp_f32 v52, v52
    v_mfma_f32_32x32x16_bf16 v[64:79], v[84:87], v[12:15], 0
    ds_read_b128 v[80:83], v6 offset:4096
    s_mov_b64 exec, s[40:41]
    ds_read_b128 v[88:91], v7 offset:4096
    ds_read_b128 v[92:95], v7 offset:4608
    s_mov_b64 exec, -1
    v_exp_f32 v53, v53
    v_exp_f32 v54, v54
    v_exp_f32 v55, v55
    v_cvt_pk_bf16_f32 v48, v48, v49
    v_cvt_pk_bf16_f32 v49, v50, v51
    v_cvt_pk_bf16_f32 v50, v52, v53
    v_cvt_pk_bf16_f32 v51, v54, v55
    v_exp_f32 v56, v56
    v_exp_f32 v57, v57
    v_mfma_f32_32x32x16_bf16 v[16:31], v[96:99], v[48:51], v[16:31]
    v_exp_f32 v58, v58
    v_exp_f32 v59, v59
    v_exp_f32 v60, v60
    v_exp_f32 v61, v61
    v_exp_f32 v62, v62
    v_exp_f32 v63, v63
    v_cvt_pk_bf16_f32 v52, v56, v57
    v_cvt_pk_bf16_f32 v53, v58, v59
    v_cvt_pk_bf16_f32 v54, v60, v61
    v_cvt_pk_bf16_f32 v55, v62, v63
    v_exp_f32 v64, v64
    v_exp_f32 v65, v65
    v_mfma_f32_32x32x16_bf16 v[16:31], v[100:103], v[52:55], v[16:31]
    v_exp_f32 v66, v66
    v_exp_f32 v67, v67
    s_waitcnt lgkmcnt(0)
    v_exp_f32 v68, v68
    v_mfma_f32_32x32x16_bf16 v[48:63], v[80:83], v[8:11], 0
    v_exp_f32 v69, v69
    v_exp_f32 v70, v70
    v_exp_f32 v71, v71
    v_cvt_pk_bf16_f32 v64, v64, v65
    v_cvt_pk_bf16_f32 v65, v66, v67
    v_cvt_pk_bf16_f32 v66, v68, v69
    v_cvt_pk_bf16_f32 v67, v70, v71
    v_exp_f32 v72, v72
    v_exp_f32 v73, v73
    v_mfma_f32_32x32x16_bf16 v[32:47], v[96:99], v[64:67], v[32:47]
    v_exp_f32 v74, v74
    v_exp_f32 v75, v75
    v_exp_f32 v76, v76
    v_exp_f32 v77, v77
    v_exp_f32 v78, v78
    v_exp_f32 v79, v79
    v_cvt_pk_bf16_f32 v68, v72, v73
    v_cvt_pk_bf16_f32 v69, v74, v75
    v_cvt_pk_bf16_f32 v70, v76, v77
    v_cvt_pk_bf16_f32 v71, v78, v79
    v_exp_f32 v48, v48
    v_exp_f32 v49, v49
    v_mfma_f32_32x32x16_bf16 v[32:47], v[100:103], v[68:71], v[32:47]
    v_exp_f32 v50, v50
    v_exp_f32 v51, v51
    v_exp_f32 v52, v52
    v_mfma_f32_32x32x16_bf16 v[64:79], v[80:83], v[12:15], 0
    ds_read_b128 v[84:87], v6 offset:5120
    s_mov_b64 exec, s[40:41]
    ds_read_b128 v[96:99], v7 offset:5120
    ds_read_b128 v[100:103], v7 offset:5632
    s_mov_b64 exec, -1
    v_exp_f32 v53, v53
    v_exp_f32 v54, v54
    v_exp_f32 v55, v55
    v_cvt_pk_bf16_f32 v48, v48, v49
    v_cvt_pk_bf16_f32 v49, v50, v51
    v_cvt_pk_bf16_f32 v50, v52, v53
    v_cvt_pk_bf16_f32 v51, v54, v55
    v_exp_f32 v56, v56
    v_exp_f32 v57, v57
    v_mfma_f32_32x32x16_bf16 v[16:31], v[88:91], v[48:51], v[16:31]
    v_exp_f32 v58, v58
    v_exp_f32 v59, v59
    v_exp_f32 v60, v60
    v_exp_f32 v61, v61
    v_exp_f32 v62, v62
    v_exp_f32 v63, v63
    v_cvt_pk_bf16_f32 v52, v56, v57
    v_cvt_pk_bf16_f32 v53, v58, v59
    v_cvt_pk_bf16_f32 v54, v60, v61
    v_cvt_pk_bf16_f32 v55, v62, v63
    v_exp_f32 v64, v64
    v_exp_f32 v65, v65
    v_mfma_f32_32x32x16_bf16 v[16:31], v[92:95], v[52:55], v[16:31]
    v_exp_f32 v66, v66
    v_exp_f32 v67, v67
    s_waitcnt lgkmcnt(0)
    v_exp_f32 v68, v68
    v_mfma_f32_32x32x16_bf16 v[48:63], v[84:87], v[8:11], 0
    v_exp_f32 v69, v69
    v_exp_f32 v70, v70
    v_exp_f32 v71, v71
    v_cvt_pk_bf16_f32 v64, v64, v65
    v_cvt_pk_bf16_f32 v65, v66, v67
    v_cvt_pk_bf16_f32 v66, v68, v69
    v_cvt_pk_bf16_f32 v67, v70, v71
    v_exp_f32 v72, v72
    v_exp_f32 v73, v73
    v_mfma_f32_32x32x16_bf16 v[32:47], v[88:91], v[64:67], v[32:47]
    v_exp_f32 v74, v74
    v_exp_f32 v75, v75
    v_exp_f32 v76, v76
    v_exp_f32 v77, v77
    v_exp_f32 v78, v78
    v_exp_f32 v79, v79
    v_cvt_pk_bf16_f32 v68, v72, v73
    v_cvt_pk_bf16_f32 v69, v74, v75
    v_cvt_pk_bf16_f32 v70, v76, v77
    v_cvt_pk_bf16_f32 v71, v78, v79
    v_exp_f32 v48, v48
    v_exp_f32 v49, v49
    v_mfma_f32_32x32x16_bf16 v[32:47], v[92:95], v[68:71], v[32:47]
    v_exp_f32 v50, v50
    v_exp_f32 v51, v51
    v_exp_f32 v52, v52
    v_mfma_f32_32x32x16_bf16 v[64:79], v[84:87], v[12:15], 0
    ds_read_b128 v[80:83], v6 offset:6144
    s_mov_b64 exec, s[40:41]
    ds_read_b128 v[88:91], v7 offset:6144
    ds_read_b128 v[92:95], v7 offset:6656
    s_mov_b64 exec, -1
    v_exp_f32 v53, v53
    v_exp_f32 v54, v54
    v_exp_f32 v55, v55
    v_cvt_pk_bf16_f32 v48, v48, v49
    v_cvt_pk_bf16_f32 v49, v50, v51
    v_cvt_pk_bf16_f32 v50, v52, v53
    v_cvt_pk_bf16_f32 v51, v54, v55
    v_exp_f32 v56, v56
    v_exp_f32 v57, v57
    v_mfma_f32_32x32x16_bf16 v[16:31], v[96:99], v[48:51], v[16:31]
    v_exp_f32 v58, v58
    v_exp_f32 v59, v59
    v_exp_f32 v60, v60
    v_exp_f32 v61, v61
    v_exp_f32 v62, v62
    v_exp_f32 v63, v63
    v_cvt_pk_bf16_f32 v52, v56, v57
    v_cvt_pk_bf16_f32 v53, v58, v59
    v_cvt_pk_bf16_f32 v54, v60, v61
    v_cvt_pk_bf16_f32 v55, v62, v63
    v_exp_f32 v64, v64
    v_exp_f32 v65, v65
    v_mfma_f32_32x32x16_bf16 v[16:31], v[100:103], v[52:55], v[16:31]
    v_exp_f32 v66, v66
    v_exp_f32 v67, v67
    s_waitcnt lgkmcnt(0)
    v_exp_f32 v68, v68
    v_mfma_f32_32x32x16_bf16 v[48:63], v[80:83], v[8:11], 0
    v_exp_f32 v69, v69
    v_exp_f32 v70, v70
    v_exp_f32 v71, v71
    v_cvt_pk_bf16_f32 v64, v64, v65
    v_cvt_pk_bf16_f32 v65, v66, v67
    v_cvt_pk_bf16_f32 v66, v68, v69
    v_cvt_pk_bf16_f32 v67, v70, v71
    v_exp_f32 v72, v72
    v_exp_f32 v73, v73
    v_mfma_f32_32x32x16_bf16 v[32:47], v[96:99], v[64:67], v[32:47]
    v_exp_f32 v74, v74
    v_exp_f32 v75, v75
    v_exp_f32 v76, v76
    v_exp_f32 v77, v77
    v_exp_f32 v78, v78
    v_exp_f32 v79, v79
    v_cvt_pk_bf16_f32 v68, v72, v73
    v_cvt_pk_bf16_f32 v69, v74, v75
    v_cvt_pk_bf16_f32 v70, v76, v77
    v_cvt_pk_bf16_f32 v71, v78, v79
    v_exp_f32 v48, v48
    v_exp_f32 v49, v49
    v_mfma_f32_32x32x16_bf16 v[32:47], v[100:103], v[68:71], v[32:47]
    v_exp_f32 v50, v50
    v_exp_f32 v51, v51
    v_exp_f32 v52, v52
    v_mfma_f32_32x32x16_bf16 v[64:79], v[80:83], v[12:15], 0
    ds_read_b128 v[84:87], v6 offset:7168
    s_mov_b64 exec, s[40:41]
    ds_read_b128 v[96:99], v7 offset:7168
    ds_read_b128 v[100:103], v7 offset:7680
    s_mov_b64 exec, -1
    v_exp_f32 v53, v53
    v_exp_f32 v54, v54
    v_exp_f32 v55, v55
    v_cvt_pk_bf16_f32 v48, v48, v49
    v_cvt_pk_bf16_f32 v49, v50, v51
    v_cvt_pk_bf16_f32 v50, v52, v53
    v_cvt_pk_bf16_f32 v51, v54, v55
    v_exp_f32 v56, v56
    v_exp_f32 v57, v57
    v_mfma_f32_32x32x16_bf16 v[16:31], v[88:91], v[48:51], v[16:31]
    v_exp_f32 v58, v58
    v_exp_f32 v59, v59
    v_exp_f32 v60, v60
    v_exp_f32 v61, v61
    v_exp_f32 v62, v62
    v_exp_f32 v63, v63
    v_cvt_pk_bf16_f32 v52, v56, v57
    v_cvt_pk_bf16_f32 v53, v58, v59
    v_cvt_pk_bf16_f32 v54, v60, v61
    v_cvt_pk_bf16_f32 v55, v62, v63
    v_exp_f32 v64, v64
    v_exp_f32 v65, v65
    v_mfma_f32_32x32x16_bf16 v[16:31], v[92:95], v[52:55], v[16:31]
    v_exp_f32 v66, v66
    v_exp_f32 v67, v67
    s_waitcnt lgkmcnt(0)
    v_exp_f32 v68, v68
    v_mfma_f32_32x32x16_bf16 v[48:63], v[84:87], v[8:11], 0
    v_exp_f32 v69, v69
    v_exp_f32 v70, v70
    v_exp_f32 v71, v71
    v_cvt_pk_bf16_f32 v64, v64, v65
    v_cvt_pk_bf16_f32 v65, v66, v67
    v_cvt_pk_bf16_f32 v66, v68, v69
    v_cvt_pk_bf16_f32 v67, v70, v71
    v_exp_f32 v72, v72
    v_exp_f32 v73, v73
    v_mfma_f32_32x32x16_bf16 v[32:47], v[88:91], v[64:67], v[32:47]
    v_exp_f32 v74, v74
    v_exp_f32 v75, v75
    v_exp_f32 v76, v76
    v_exp_f32 v77, v77
    v_exp_f32 v78, v78
    v_exp_f32 v79, v79
    v_cvt_pk_bf16_f32 v68, v72, v73
    v_cvt_pk_bf16_f32 v69, v74, v75
    v_cvt_pk_bf16_f32 v70, v76, v77
    v_cvt_pk_bf16_f32 v71, v78, v79
    v_exp_f32 v48, v48
    v_exp_f32 v49, v49
    v_mfma_f32_32x32x16_bf16 v[32:47], v[92:95], v[68:71], v[32:47]
    v_exp_f32 v50, v50
    v_exp_f32 v51, v51
    v_exp_f32 v52, v52
    v_mfma_f32_32x32x16_bf16 v[64:79], v[84:87], v[12:15], 0
    ds_read_b128 v[80:83], v6 offset:8192
    s_mov_b64 exec, s[40:41]
    ds_read_b128 v[88:91], v7 offset:8192
    ds_read_b128 v[92:95], v7 offset:8704
    s_mov_b64 exec, -1
    v_exp_f32 v53, v53
    v_exp_f32 v54, v54
    v_exp_f32 v55, v55
    v_cvt_pk_bf16_f32 v48, v48, v49
    v_cvt_pk_bf16_f32 v49, v50, v51
    v_cvt_pk_bf16_f32 v50, v52, v53
    v_cvt_pk_bf16_f32 v51, v54, v55
    v_exp_f32 v56, v56
    v_exp_f32 v57, v57
    v_mfma_f32_32x32x16_bf16 v[16:31], v[96:99], v[48:51], v[16:31]
    v_exp_f32 v58, v58
    v_exp_f32 v59, v59
    v_exp_f32 v60, v60
    v_exp_f32 v61, v61
    v_exp_f32 v62, v62
    v_exp_f32 v63, v63
    v_cvt_pk_bf16_f32 v52, v56, v57
    v_cvt_pk_bf16_f32 v53, v58, v59
    v_cvt_pk_bf16_f32 v54, v60, v61
    v_cvt_pk_bf16_f32 v55, v62, v63
    v_exp_f32 v64, v64
    v_exp_f32 v65, v65
    v_mfma_f32_32x32x16_bf16 v[16:31], v[100:103], v[52:55], v[16:31]
    v_exp_f32 v66, v66
    v_exp_f32 v67, v67
    s_waitcnt lgkmcnt(0)
    v_exp_f32 v68, v68
    v_mfma_f32_32x32x16_bf16 v[48:63], v[80:83], v[8:11], 0
    v_exp_f32 v69, v69
    v_exp_f32 v70, v70
    v_exp_f32 v71, v71
    v_cvt_pk_bf16_f32 v64, v64, v65
    v_cvt_pk_bf16_f32 v65, v66, v67
    v_cvt_pk_bf16_f32 v66, v68, v69
    v_cvt_pk_bf16_f32 v67, v70, v71
    v_exp_f32 v72, v72
    v_exp_f32 v73, v73
    v_mfma_f32_32x32x16_bf16 v[32:47], v[96:99], v[64:67], v[32:47]
    v_exp_f32 v74, v74
    v_exp_f32 v75, v75
    v_exp_f32 v76, v76
    v_exp_f32 v77, v77
    v_exp_f32 v78, v78
    v_exp_f32 v79, v79
    v_cvt_pk_bf16_f32 v68, v72, v73
    v_cvt_pk_bf16_f32 v69, v74, v75
    v_cvt_pk_bf16_f32 v70, v76, v77
    v_cvt_pk_bf16_f32 v71, v78, v79
    v_add_u32 v6, 8192, v6
    v_add_u32 v7, 8192, v7
    s_sub_u32 s36, s36, 1
    s_cmp_eq_u32 s36, 7
    s_cbranch_scc1 L_p23_kernel_Ab
    s_cmp_eq_u32 s36, 2
    s_cbranch_scc1 L_p23_kernel_Ag
    s_cmp_lg_u32 s36, 0
    s_cbranch_scc1 L_p23_kernel_Af
    s_branch L_p23_kernel_Alast
L_p23_kernel_Ab:
    s_barrier
    s_branch L_p23_kernel_Af
L_p23_kernel_Ag:
    s_barrier
    s_lshl_b32 s28, s24, 10
    s_add_u32 s28, s28, 2237312
    v_and_b32 v3, 3, v1
    v_lshlrev_b32 v3, 2, v3
    buffer_load_dword v225, v3, s[12:15], s28 offen sc0 sc1
    s_branch L_p23_kernel_Af
L_p23_kernel_Alast:
    s_nop 1
    v_mfma_f32_32x32x16_bf16 v[32:47], v[100:103], v[68:71], v[32:47]
    s_branch L_p23_kernel_Afin
L_p23_kernel_slow:
    v_mov_b32 v104, 0xf149f2ca
    v_mov_b32 v105, 0xf149f2ca
    s_barrier
    s_mov_b32 s36, 64
L_p23_kernel_As:
    ds_read_b128 v[80:83], v6 offset:0
    s_mov_b64 exec, s[40:41]
    ds_read_b128 v[88:91], v7 offset:0
    ds_read_b128 v[92:95], v7 offset:512
    s_mov_b64 exec, -1
    s_waitcnt lgkmcnt(0)
    v_mfma_f32_32x32x16_bf16 v[48:63], v[80:83], v[8:11], 0
    s_nop 13
    v_max3_f32 v2, v48, v49, v50
    v_max3_f32 v2, v51, v52, v2
    v_max3_f32 v2, v53, v54, v2
    v_max3_f32 v2, v55, v56, v2
    v_max3_f32 v2, v57, v58, v2
    v_max3_f32 v2, v59, v60, v2
    v_max3_f32 v2, v61, v62, v2
    v_max_f32 v2, v63, v2
    v_mov_b32 v3, v2
    s_nop 1
    v_permlane32_swap_b32 v3, v2
    s_nop 1
    v_max3_f32 v2, v2, v3, v104
    v_sub_f32 v3, v104, v2
    v_exp_f32 v3, v3
    v_mov_b32 v104, v2
    v_sub_f32 v48, v48, v2
    v_sub_f32 v49, v49, v2
    v_sub_f32 v50, v50, v2
    v_sub_f32 v51, v51, v2
    v_sub_f32 v52, v52, v2
    v_sub_f32 v53, v53, v2
    v_sub_f32 v54, v54, v2
    v_sub_f32 v55, v55, v2
    v_sub_f32 v56, v56, v2
    v_sub_f32 v57, v57, v2
    v_sub_f32 v58, v58, v2
    v_sub_f32 v59, v59, v2
    v_sub_f32 v60, v60, v2
    v_sub_f32 v61, v61, v2
    v_sub_f32 v62, v62, v2
    v_sub_f32 v63, v63, v2
    v_exp_f32 v48, v48
    v_exp_f32 v49, v49
    v_exp_f32 v50, v50
    v_exp_f32 v51, v51
    v_exp_f32 v52, v52
    v_exp_f32 v53, v53
    v_exp_f32 v54, v54
    v_exp_f32 v55, v55
    v_exp_f32 v56, v56
    v_exp_f32 v57, v57
    v_exp_f32 v58, v58
    v_exp_f32 v59, v59
    v_exp_f32 v60, v60
    v_exp_f32 v61, v61
    v_exp_f32 v62, v62
    v_exp_f32 v63, v63
    v_mul_f32 v16, v16, v3
    v_mul_f32 v17, v17, v3
    v_mul_f32 v18, v18, v3
    v_mul_f32 v19, v19, v3
    v_mul_f32 v20, v20, v3
    v_mul_f32 v21, v21, v3
    v_mul_f32 v22, v22, v3
    v_mul_f32 v23, v23, v3
    v_mul_f32 v24, v24, v3
    v_cvt_pk_bf16_f32 v48, v48, v49
    v_cvt_pk_bf16_f32 v49, v50, v51
    v_cvt_pk_bf16_f32 v50, v52, v53
    v_cvt_pk_bf16_f32 v51, v54, v55
    v_cvt_pk_bf16_f32 v52, v56, v57
    v_cvt_pk_bf16_f32 v53, v58, v59
    v_cvt_pk_bf16_f32 v54, v60, v61
    v_cvt_pk_bf16_f32 v55, v62, v63
    s_nop 1
    v_mfma_f32_32x32x16_bf16 v[16:31], v[88:91], v[48:51], v[16:31]
    v_mfma_f32_32x32x16_bf16 v[16:31], v[92:95], v[52:55], v[16:31]
    s_nop 3
    v_mfma_f32_32x32x16_bf16 v[48:63], v[80:83], v[12:15], 0
    s_nop 13
    v_max3_f32 v2, v48, v49, v50
    v_max3_f32 v2, v51, v52, v2
    v_max3_f32 v2, v53, v54, v2
    v_max3_f32 v2, v55, v56, v2
    v_max3_f32 v2, v57, v58, v2
    v_max3_f32 v2, v59, v60, v2
    v_max3_f32 v2, v61, v62, v2
    v_max_f32 v2, v63, v2
    v_mov_b32 v3, v2
    s_nop 1
    v_permlane32_swap_b32 v3, v2
    s_nop 1
    v_max3_f32 v2, v2, v3, v105
    v_sub_f32 v3, v105, v2
    v_exp_f32 v3, v3
    v_mov_b32 v105, v2
    v_sub_f32 v48, v48, v2
    v_sub_f32 v49, v49, v2
    v_sub_f32 v50, v50, v2
    v_sub_f32 v51, v51, v2
    v_sub_f32 v52, v52, v2
    v_sub_f32 v53, v53, v2
    v_sub_f32 v54, v54, v2
    v_sub_f32 v55, v55, v2
    v_sub_f32 v56, v56, v2
    v_sub_f32 v57, v57, v2
    v_sub_f32 v58, v58, v2
    v_sub_f32 v59, v59, v2
    v_sub_f32 v60, v60, v2
    v_sub_f32 v61, v61, v2
    v_sub_f32 v62, v62, v2
    v_sub_f32 v63, v63, v2
    v_exp_f32 v48, v48
    v_exp_f32 v49, v49
    v_exp_f32 v50, v50
    v_exp_f32 v51, v51
    v_exp_f32 v52, v52
    v_exp_f32 v53, v53
    v_exp_f32 v54, v54
    v_exp_f32 v55, v55
    v_exp_f32 v56, v56
    v_exp_f32 v57, v57
    v_exp_f32 v58, v58
    v_exp_f32 v59, v59
    v_exp_f32 v60, v60
    v_exp_f32 v61, v61
    v_exp_f32 v62, v62
    v_exp_f32 v63, v63
    v_mul_f32 v32, v32, v3
    v_mul_f32 v33, v33, v3
    v_mul_f32 v34, v34, v3
    v_mul_f32 v35, v35, v3
    v_mul_f32 v36, v36, v3
    v_mul_f32 v37, v37, v3
    v_mul_f32 v38, v38, v3
    v_mul_f32 v39, v39, v3
    v_mul_f32 v40, v40, v3
    v_cvt_pk_bf16_f32 v48, v48, v49
    v_cvt_pk_bf16_f32 v49, v50, v51
    v_cvt_pk_bf16_f32 v50, v52, v53
    v_cvt_pk_bf16_f32 v51, v54, v55
    v_cvt_pk_bf16_f32 v52, v56, v57
    v_cvt_pk_bf16_f32 v53, v58, v59
    v_cvt_pk_bf16_f32 v54, v60, v61
    v_cvt_pk_bf16_f32 v55, v62, v63
    s_nop 1
    v_mfma_f32_32x32x16_bf16 v[32:47], v[88:91], v[48:51], v[32:47]
    v_mfma_f32_32x32x16_bf16 v[32:47], v[92:95], v[52:55], v[32:47]
    s_nop 3
    v_add_u32 v6, 1024, v6
    v_add_u32 v7, 1024, v7
    s_nop 9
    s_sub_u32 s36, s36, 1
    s_cmp_eq_u32 s36, 15
    s_cbranch_scc0 L_p23_kernel_As2
    s_barrier
    s_lshl_b32 s28, s24, 10
    s_add_u32 s28, s28, 2237312
    v_and_b32 v3, 3, v1
    v_lshlrev_b32 v3, 2, v3
    buffer_load_dword v225, v3, s[12:15], s28 offen sc0 sc1
L_p23_kernel_As2:
    s_cmp_lg_u32 s36, 0
    s_cbranch_scc1 L_p23_kernel_As
L_p23_kernel_Afin:
    v_lshrrev_b32 v2, 3, v0
    s_lshl_b32 s28, s24, 6
    v_add_u32 v2, s28, v2
    v_lshlrev_b32 v2, 10, v2
    v_and_b32 v3, 7, v0
    v_lshlrev_b32 v3, 4, v3
    v_add_u32 v2, v2, v3
    s_lshl_b32 s28, s25, 7
    v_add_u32 v224, s28, v2
    buffer_load_dwordx4 v[220:223], v224, s[48:51], 0 offen
    s_nop 7
    v_mov_b32 v108, v24
    v_mov_b32 v109, v40
    s_nop 0
    v_permlane32_swap_b32 v24, v108
    v_permlane32_swap_b32 v40, v109
    s_nop 0
    v_rcp_f32 v24, v24
    v_rcp_f32 v40, v40
    s_nop 0
    v_mul_f32 v16, v16, v24
    v_mul_f32 v17, v17, v24
    v_mul_f32 v18, v18, v24
    v_mul_f32 v19, v19, v24
    v_mul_f32 v20, v20, v24
    v_mul_f32 v21, v21, v24
    v_mul_f32 v22, v22, v24
    v_mul_f32 v23, v23, v24
    v_cvt_pk_bf16_f32 v16, v16, v17
    v_cvt_pk_bf16_f32 v17, v18, v19
    v_cvt_pk_bf16_f32 v18, v20, v21
    v_cvt_pk_bf16_f32 v19, v22, v23
    v_mul_f32 v32, v32, v40
    v_mul_f32 v33, v33, v40
    v_mul_f32 v34, v34, v40
    v_mul_f32 v35, v35, v40
    v_mul_f32 v36, v36, v40
    v_mul_f32 v37, v37, v40
    v_mul_f32 v38, v38, v40
    v_mul_f32 v39, v39, v40
    v_cvt_pk_bf16_f32 v32, v32, v33
    v_cvt_pk_bf16_f32 v33, v34, v35
    v_cvt_pk_bf16_f32 v34, v36, v37
    v_cvt_pk_bf16_f32 v35, v38, v39
    s_mul_i32 s30, s37, 88
    s_lshl_b32 s31, s25, 2
    s_add_u32 s30, s30, s31
    s_and_b32 s31, s27, 2
    s_add_u32 s30, s30, s31
    s_lshl_b32 s30, s30, 10
    s_add_u32 s30, s30, 13631488
    v_lshlrev_b32 v110, 4, v1
    s_waitcnt vmcnt(1)
    v_cmp_ne_u32 vcc, 1, v225
    s_cbranch_vccz L_p23_kernel_mkadone
    s_lshl_b32 s28, s24, 10
    s_add_u32 s28, s28, 2237312
    v_and_b32 v4, 3, v1
    v_lshlrev_b32 v4, 2, v4
    s_mov_b32 s29, s28
    s_mov_b32 s36, 1048576
L_p23_kernel_mka:
    buffer_load_dword v3, v4, s[12:15], s29 offen sc0 sc1
    s_waitcnt vmcnt(0)
    v_cmp_ne_u32 vcc, 1, v3
    s_sub_u32 s36, s36, 1
    s_cbranch_vccz L_p23_kernel_mkaok
    s_cmp_eq_u32 s36, 0
    s_cbranch_scc1 L_p23_kernel_mkaok
    s_sleep 1
    s_branch L_p23_kernel_mka
L_p23_kernel_mkaok:
L_p23_kernel_mkadone:
    buffer_store_dwordx4 v[16:19], v110, s[12:15], s30 offen offset:0 sc0 sc1
    buffer_store_dwordx4 v[32:35], v110, s[12:15], s30 offen offset:1024 sc0 sc1
    s_branch L_p23_kernel_red
L_p23_kernel_B:
    s_setprio 3
    s_lshl_b32 s39, s27, 13
    s_add_u32 s39, s39, 131072
    v_lshlrev_b32 v6, 4, v1
    s_lshl_b32 s37, s24, 2
    s_add_u32 s37, s37, s27
    s_cmp_eq_u32 s25, 7
    s_cbranch_scc1 L_p23_kernel_Bidle
    s_lshr_b32 s28, s37, 1
    s_lshl_b32 s28, s28, 12
    s_and_b32 s29, s37, 1
    s_lshl_b32 s29, s29, 7
    s_add_u32 s28, s28, s29
    s_add_u32 s28, s28, 2359296
    v_lshrrev_b32 v3, 4, v1
    v_lshlrev_b32 v3, 8, v3
    v_and_b32 v4, 15, v1
    v_lshlrev_b32 v4, 3, v4
    v_add_u32 v3, v3, v4
    buffer_load_dwordx2 v[204:205], v3, s[12:15], s28 offen offset:0
    buffer_load_dwordx2 v[206:207], v3, s[12:15], s28 offen offset:1024
    buffer_load_dwordx2 v[208:209], v3, s[12:15], s28 offen offset:2048
    buffer_load_dwordx2 v[210:211], v3, s[12:15], s28 offen offset:3072
    s_mul_i32 s28, s37, 28
    s_lshl_b32 s29, s25, 2
    s_add_u32 s28, s28, s29
    s_lshl_b32 s38, s28, 10
    s_add_u32 s28, s38, 6291456
    buffer_load_dwordx4 v[140:143], v6, s[12:15], s28 offen offset:0
    buffer_load_dwordx4 v[144:147], v6, s[12:15], s28 offen offset:1024
    buffer_load_dwordx4 v[148:151], v6, s[12:15], s28 offen offset:2048
    buffer_load_dwordx4 v[152:155], v6, s[12:15], s28 offen offset:3072
    v_and_b32 v2, 31, v1
    v_lshlrev_b32 v2, 1, v2
    s_lshl_b32 s28, s24, 7
    buffer_load_ushort v237, v2, s[20:23], s28 offen offset:0
    buffer_load_ushort v238, v2, s[20:23], s28 offen offset:64
    v_lshrrev_b32 v7, 3, v1
    v_lshrrev_b32 v2, 4, v1
    v_xor_b32 v2, v2, v1
    v_and_b32 v2, 7, v2
    v_lshlrev_b32 v2, 4, v2
    v_lshlrev_b32 v7, 12, v7
    v_add_u32 v7, v7, v2
    s_lshl_b32 s28, s24, 18
    s_lshl_b32 s29, s27, 10
    s_add_u32 s28, s28, s29
    v_add_u32 v7, s28, v7
    v_xor_b32 v8, 64, v7
    v_and_b32 v2, 31, v1
    v_lshrrev_b32 v3, 1, v2
    v_and_b32 v3, 7, v3
    v_lshrrev_b32 v4, 5, v1
    v_xor_b32 v3, v3, v4
    v_lshlrev_b32 v3, 4, v3
    v_lshlrev_b32 v2, 7, v2
    v_add_u32 v2, v2, v3
    v_add_u32 v9, s39, v2
    v_xor_b32 v10, 32, v9
    v_xor_b32 v11, 64, v9
    v_xor_b32 v236, 96, v9
    v_mov_b32 v12, 0
    v_mov_b32 v13, 0
    v_mov_b32 v14, 0
    v_mov_b32 v15, 0
    v_mov_b32 v16, 0
    v_mov_b32 v17, 0
    v_mov_b32 v18, 0
    v_mov_b32 v19, 0
    v_mov_b32 v20, 0
    v_mov_b32 v21, 0
    v_mov_b32 v22, 0
    v_mov_b32 v23, 0
    v_mov_b32 v24, 0
    v_mov_b32 v25, 0
    v_mov_b32 v26, 0
    v_mov_b32 v27, 0
    v_mov_b32 v28, 0
    v_mov_b32 v29, 0
    v_mov_b32 v30, 0
    v_mov_b32 v31, 0
    v_mov_b32 v32, 0
    v_mov_b32 v33, 0
    v_mov_b32 v34, 0
    v_mov_b32 v35, 0
    v_mov_b32 v36, 0
    v_mov_b32 v37, 0
    v_mov_b32 v38, 0
    v_mov_b32 v39, 0
    v_mov_b32 v40, 0
    v_mov_b32 v41, 0
    v_mov_b32 v42, 0
    v_mov_b32 v43, 0
    v_mov_b32 v44, 0
    v_mov_b32 v45, 0
    v_mov_b32 v46, 0
    v_mov_b32 v47, 0
    v_mov_b32 v48, 0
    v_mov_b32 v49, 0
    v_mov_b32 v50, 0
    v_mov_b32 v51, 0
    v_mov_b32 v52, 0
    v_mov_b32 v53, 0
    v_mov_b32 v54, 0
    v_mov_b32 v55, 0
    v_mov_b32 v56, 0
    v_mov_b32 v57, 0
    v_mov_b32 v58, 0
    v_mov_b32 v59, 0
    v_mov_b32 v60, 0
    v_mov_b32 v61, 0
    v_mov_b32 v62, 0
    v_mov_b32 v63, 0
    v_mov_b32 v64, 0
    v_mov_b32 v65, 0
    v_mov_b32 v66, 0
    v_mov_b32 v67, 0
    v_mov_b32 v68, 0
    v_mov_b32 v69, 0
    v_mov_b32 v70, 0
    v_mov_b32 v71, 0
    v_mov_b32 v72, 0
    v_mov_b32 v73, 0
    v_mov_b32 v74, 0
    v_mov_b32 v75, 0
    v_mov_b32 v76, 0
    v_mov_b32 v77, 0
    v_mov_b32 v78, 0
    v_mov_b32 v79, 0
    v_mov_b32 v80, 0
    v_mov_b32 v81, 0
    v_mov_b32 v82, 0
    v_mov_b32 v83, 0
    v_mov_b32 v84, 0
    v_mov_b32 v85, 0
    v_mov_b32 v86, 0
    v_mov_b32 v87, 0
    v_mov_b32 v88, 0
    v_mov_b32 v89, 0
    v_mov_b32 v90, 0
    v_mov_b32 v91, 0
    v_mov_b32 v92, 0
    v_mov_b32 v93, 0
    v_mov_b32 v94, 0
    v_mov_b32 v95, 0
    v_mov_b32 v96, 0
    v_mov_b32 v97, 0
    v_mov_b32 v98, 0
    v_mov_b32 v99, 0
    v_mov_b32 v100, 0
    v_mov_b32 v101, 0
    v_mov_b32 v102, 0
    v_mov_b32 v103, 0
    v_mov_b32 v104, 0
    v_mov_b32 v105, 0
    v_mov_b32 v106, 0
    v_mov_b32 v107, 0
    v_mov_b32 v108, 0
    v_mov_b32 v109, 0
    v_mov_b32 v110, 0
    v_mov_b32 v111, 0
    v_mov_b32 v112, 0
    v_mov_b32 v113, 0
    v_mov_b32 v114, 0
    v_mov_b32 v115, 0
    v_mov_b32 v116, 0
    v_mov_b32 v117, 0
    v_mov_b32 v118, 0
    v_mov_b32 v119, 0
    v_mov_b32 v120, 0
    v_mov_b32 v121, 0
    v_mov_b32 v122, 0
    v_mov_b32 v123, 0
    v_mov_b32 v124, 0
    v_mov_b32 v125, 0
    v_mov_b32 v126, 0
    v_mov_b32 v127, 0
    v_mov_b32 v128, 0
    v_mov_b32 v129, 0
    v_mov_b32 v130, 0
    v_mov_b32 v131, 0
    v_mov_b32 v132, 0
    v_mov_b32 v133, 0
    v_mov_b32 v134, 0
    v_mov_b32 v135, 0
    v_mov_b32 v136, 0
    v_mov_b32 v137, 0
    v_mov_b32 v138, 0
    v_mov_b32 v139, 0
    s_barrier
    s_waitcnt vmcnt(6)
    v_add_f32 v204, v204, v206
    v_add_f32 v205, v205, v207
    v_add_f32 v208, v208, v210
    v_add_f32 v209, v209, v211
    v_add_f32 v204, v204, v208
    v_add_f32 v205, v205, v209
    v_mov_b32 v2, v204
    s_nop 1
    v_permlane16_swap_b32 v2, v204
    s_nop 1
    v_add_f32 v204, v204, v2
    v_mov_b32 v2, v204
    s_nop 1
    v_permlane32_swap_b32 v2, v204
    s_nop 1
    v_add_f32 v204, v204, v2
    v_mov_b32 v2, v205
    s_nop 1
    v_permlane16_swap_b32 v2, v205
    s_nop 1
    v_add_f32 v205, v205, v2
    v_mov_b32 v2, v205
    s_nop 1
    v_permlane32_swap_b32 v2, v205
    s_nop 1
    v_add_f32 v205, v205, v2
    v_mul_f32 v204, 0x3a924925, v204
    v_mul_f32 v205, 0x3a924925, v205
    v_fma_f32 v205, -v204, v204, v205
    v_max_f32 v205, 0, v205
    v_add_f32 v205, 0x3727c5ac, v205
    v_rsq_f32 v205, v205
    s_nop 0
    v_mul_f32 v204, v204, v205
    v_sub_f32 v204, 0, v204
    s_nop 1
    v_mov_b32_dpp v204, v204 row_ror:8 row_mask:0xc bank_mask:0xf
    v_mov_b32_dpp v205, v205 row_ror:8 row_mask:0xc bank_mask:0xf
    s_nop 1
    v_mov_b32_dpp v212, v205 row_newbcast:0 row_mask:0xf bank_mask:0xf
    v_mov_b32_dpp v220, v204 row_newbcast:0 row_mask:0xf bank_mask:0xf
    v_mov_b32_dpp v213, v205 row_newbcast:1 row_mask:0xf bank_mask:0xf
    v_mov_b32_dpp v221, v204 row_newbcast:1 row_mask:0xf bank_mask:0xf
    v_mov_b32_dpp v214, v205 row_newbcast:2 row_mask:0xf bank_mask:0xf
    v_mov_b32_dpp v222, v204 row_newbcast:2 row_mask:0xf bank_mask:0xf
    v_mov_b32_dpp v215, v205 row_newbcast:3 row_mask:0xf bank_mask:0xf
    v_mov_b32_dpp v223, v204 row_newbcast:3 row_mask:0xf bank_mask:0xf
    v_mov_b32_dpp v216, v205 row_newbcast:4 row_mask:0xf bank_mask:0xf
    v_mov_b32_dpp v224, v204 row_newbcast:4 row_mask:0xf bank_mask:0xf
    v_mov_b32_dpp v217, v205 row_newbcast:5 row_mask:0xf bank_mask:0xf
    v_mov_b32_dpp v225, v204 row_newbcast:5 row_mask:0xf bank_mask:0xf
    v_mov_b32_dpp v218, v205 row_newbcast:6 row_mask:0xf bank_mask:0xf
    v_mov_b32_dpp v226, v204 row_newbcast:6 row_mask:0xf bank_mask:0xf
    v_mov_b32_dpp v219, v205 row_newbcast:7 row_mask:0xf bank_mask:0xf
    v_mov_b32_dpp v227, v204 row_newbcast:7 row_mask:0xf bank_mask:0xf
    s_waitcnt vmcnt(0)
    v_lshlrev_b32 v237, 16, v237
    v_lshlrev_b32 v238, 16, v238
    s_cmp_eq_u32 s27, 0
    s_cbranch_scc0 L_p23_kernel_bi0
    v_mov_b32 v12, v237
    v_mov_b32 v13, v237
    v_mov_b32 v14, v237
    v_mov_b32 v15, v237
    v_mov_b32 v16, v237
    v_mov_b32 v17, v237
    v_mov_b32 v18, v237
    v_mov_b32 v19, v237
    v_mov_b32 v20, v237
    v_mov_b32 v21, v237
    v_mov_b32 v22, v237
    v_mov_b32 v23, v237
    v_mov_b32 v24, v237
    v_mov_b32 v25, v237
    v_mov_b32 v26, v237
    v_mov_b32 v27, v237
    v_mov_b32 v28, v238
    v_mov_b32 v29, v238
    v_mov_b32 v30, v238
    v_mov_b32 v31, v238
    v_mov_b32 v32, v238
    v_mov_b32 v33, v238
    v_mov_b32 v34, v238
    v_mov_b32 v35, v238
    v_mov_b32 v36, v238
    v_mov_b32 v37, v238
    v_mov_b32 v38, v238
    v_mov_b32 v39, v238
    v_mov_b32 v40, v238
    v_mov_b32 v41, v238
    v_mov_b32 v42, v238
    v_mov_b32 v43, v238
L_p23_kernel_bi0:
    s_cmp_eq_u32 s27, 1
    s_cbranch_scc0 L_p23_kernel_bi1
    v_mov_b32 v44, v237
    v_mov_b32 v45, v237
    v_mov_b32 v46, v237
    v_mov_b32 v47, v237
    v_mov_b32 v48, v237
    v_mov_b32 v49, v237
    v_mov_b32 v50, v237
    v_mov_b32 v51, v237
    v_mov_b32 v52, v237
    v_mov_b32 v53, v237
    v_mov_b32 v54, v237
    v_mov_b32 v55, v237
    v_mov_b32 v56, v237
    v_mov_b32 v57, v237
    v_mov_b32 v58, v237
    v_mov_b32 v59, v237
    v_mov_b32 v60, v238
    v_mov_b32 v61, v238
    v_mov_b32 v62, v238
    v_mov_b32 v63, v238
    v_mov_b32 v64, v238
    v_mov_b32 v65, v238
    v_mov_b32 v66, v238
    v_mov_b32 v67, v238
    v_mov_b32 v68, v238
    v_mov_b32 v69, v238
    v_mov_b32 v70, v238
    v_mov_b32 v71, v238
    v_mov_b32 v72, v238
    v_mov_b32 v73, v238
    v_mov_b32 v74, v238
    v_mov_b32 v75, v238
L_p23_kernel_bi1:
    s_cmp_eq_u32 s27, 2
    s_cbranch_scc0 L_p23_kernel_bi2
    v_mov_b32 v76, v237
    v_mov_b32 v77, v237
    v_mov_b32 v78, v237
    v_mov_b32 v79, v237
    v_mov_b32 v80, v237
    v_mov_b32 v81, v237
    v_mov_b32 v82, v237
    v_mov_b32 v83, v237
    v_mov_b32 v84, v237
    v_mov_b32 v85, v237
    v_mov_b32 v86, v237
    v_mov_b32 v87, v237
    v_mov_b32 v88, v237
    v_mov_b32 v89, v237
    v_mov_b32 v90, v237
    v_mov_b32 v91, v237
    v_mov_b32 v92, v238
    v_mov_b32 v93, v238
    v_mov_b32 v94, v238
    v_mov_b32 v95, v238
    v_mov_b32 v96, v238
    v_mov_b32 v97, v238
    v_mov_b32 v98, v238
    v_mov_b32 v99, v238
    v_mov_b32 v100, v238
    v_mov_b32 v101, v238
    v_mov_b32 v102, v238
    v_mov_b32 v103, v238
    v_mov_b32 v104, v238
    v_mov_b32 v105, v238
    v_mov_b32 v106, v238
    v_mov_b32 v107, v238
L_p23_kernel_bi2:
    s_cmp_eq_u32 s27, 3
    s_cbranch_scc0 L_p23_kernel_bi3
    v_mov_b32 v108, v237
    v_mov_b32 v109, v237
    v_mov_b32 v110, v237
    v_mov_b32 v111, v237
    v_mov_b32 v112, v237
    v_mov_b32 v113, v237
    v_mov_b32 v114, v237
    v_mov_b32 v115, v237
    v_mov_b32 v116, v237
    v_mov_b32 v117, v237
    v_mov_b32 v118, v237
    v_mov_b32 v119, v237
    v_mov_b32 v120, v237
    v_mov_b32 v121, v237
    v_mov_b32 v122, v237
    v_mov_b32 v123, v237
    v_mov_b32 v124, v238
    v_mov_b32 v125, v238
    v_mov_b32 v126, v238
    v_mov_b32 v127, v238
    v_mov_b32 v128, v238
    v_mov_b32 v129, v238
    v_mov_b32 v130, v238
    v_mov_b32 v131, v238
    v_mov_b32 v132, v238
    v_mov_b32 v133, v238
    v_mov_b32 v134, v238
    v_mov_b32 v135, v238
    v_mov_b32 v136, v238
    v_mov_b32 v137, v238
    v_mov_b32 v138, v238
    v_mov_b32 v139, v238
L_p23_kernel_bi3:
    v_lshlrev_b32 v228, 16, v140
    v_and_b32 v229, 0xffff0000, v140
    v_fma_f32 v228, v228, v212, v220
    v_fma_f32 v229, v229, v213, v221
    v_cvt_pk_bf16_f32 v140, v228, v229
    v_lshlrev_b32 v228, 16, v141
    v_and_b32 v229, 0xffff0000, v141
    v_fma_f32 v228, v228, v214, v222
    v_fma_f32 v229, v229, v215, v223
    v_cvt_pk_bf16_f32 v141, v228, v229
    v_lshlrev_b32 v228, 16, v142
    v_and_b32 v229, 0xffff0000, v142
    v_fma_f32 v228, v228, v216, v224
    v_fma_f32 v229, v229, v217, v225
    v_cvt_pk_bf16_f32 v142, v228, v229
    v_lshlrev_b32 v228, 16, v143
    v_and_b32 v229, 0xffff0000, v143
    v_fma_f32 v228, v228, v218, v226
    v_fma_f32 v229, v229, v219, v227
    v_cvt_pk_bf16_f32 v143, v228, v229
    v_lshlrev_b32 v228, 16, v144
    v_and_b32 v229, 0xffff0000, v144
    v_fma_f32 v228, v228, v212, v220
    v_fma_f32 v229, v229, v213, v221
    v_cvt_pk_bf16_f32 v144, v228, v229
    v_lshlrev_b32 v228, 16, v145
    v_and_b32 v229, 0xffff0000, v145
    v_fma_f32 v228, v228, v214, v222
    v_fma_f32 v229, v229, v215, v223
    v_cvt_pk_bf16_f32 v145, v228, v229
    v_lshlrev_b32 v228, 16, v146
    v_and_b32 v229, 0xffff0000, v146
    v_fma_f32 v228, v228, v216, v224
    v_fma_f32 v229, v229, v217, v225
    v_cvt_pk_bf16_f32 v146, v228, v229
    v_lshlrev_b32 v228, 16, v147
    v_and_b32 v229, 0xffff0000, v147
    v_fma_f32 v228, v228, v218, v226
    v_fma_f32 v229, v229, v219, v227
    v_cvt_pk_bf16_f32 v147, v228, v229
    v_lshlrev_b32 v228, 16, v148
    v_and_b32 v229, 0xffff0000, v148
    v_fma_f32 v228, v228, v212, v220
    v_fma_f32 v229, v229, v213, v221
    v_cvt_pk_bf16_f32 v148, v228, v229
    v_lshlrev_b32 v228, 16, v149
    v_and_b32 v229, 0xffff0000, v149
    v_fma_f32 v228, v228, v214, v222
    v_fma_f32 v229, v229, v215, v223
    v_cvt_pk_bf16_f32 v149, v228, v229
    v_lshlrev_b32 v228, 16, v150
    v_and_b32 v229, 0xffff0000, v150
    v_fma_f32 v228, v228, v216, v224
    v_fma_f32 v229, v229, v217, v225
    v_cvt_pk_bf16_f32 v150, v228, v229
    v_lshlrev_b32 v228, 16, v151
    v_and_b32 v229, 0xffff0000, v151
    v_fma_f32 v228, v228, v218, v226
    v_fma_f32 v229, v229, v219, v227
    v_cvt_pk_bf16_f32 v151, v228, v229
    v_lshlrev_b32 v228, 16, v152
    v_and_b32 v229, 0xffff0000, v152
    v_fma_f32 v228, v228, v212, v220
    v_fma_f32 v229, v229, v213, v221
    v_cvt_pk_bf16_f32 v152, v228, v229
    v_lshlrev_b32 v228, 16, v153
    v_and_b32 v229, 0xffff0000, v153
    v_fma_f32 v228, v228, v214, v222
    v_fma_f32 v229, v229, v215, v223
    v_cvt_pk_bf16_f32 v153, v228, v229
    v_lshlrev_b32 v228, 16, v154
    v_and_b32 v229, 0xffff0000, v154
    v_fma_f32 v228, v228, v216, v224
    v_fma_f32 v229, v229, v217, v225
    v_cvt_pk_bf16_f32 v154, v228, v229
    v_lshlrev_b32 v228, 16, v155
    v_and_b32 v229, 0xffff0000, v155
    v_fma_f32 v228, v228, v218, v226
    v_fma_f32 v229, v229, v219, v227
    v_cvt_pk_bf16_f32 v155, v228, v229
    s_add_u32 s28, s38, 9961472
    buffer_store_dwordx4 v[140:143], v6, s[12:15], s28 offen offset:0 sc0 sc1
    buffer_store_dwordx4 v[144:147], v6, s[12:15], s28 offen offset:1024 sc0 sc1
    buffer_store_dwordx4 v[148:151], v6, s[12:15], s28 offen offset:2048 sc0 sc1
    buffer_store_dwordx4 v[152:155], v6, s[12:15], s28 offen offset:3072 sc0 sc1
    s_mov_b32 s43, 0
    v_lshlrev_b32 v2, 4, v1
    s_lshr_b32 s28, s27, 1
    s_lshl_b32 s28, s28, 16
    s_and_b32 s29, s27, 1
    s_mul_i32 s29, s29, 24576
    s_add_u32 s28, s28, s29
    s_add_u32 s28, s28, 16384
    s_add_u32 s29, s28, 2097152
    s_add_u32 m0, s28, 0
    s_add_u32 s30, s29, 0
    buffer_load_dwordx4 v2, s[12:15], s30 offen lds
    s_add_u32 m0, s28, 1024
    s_add_u32 s30, s29, 1024
    buffer_load_dwordx4 v2, s[12:15], s30 offen lds
    s_add_u32 m0, s28, 2048
    s_add_u32 s30, s29, 2048
    buffer_load_dwordx4 v2, s[12:15], s30 offen lds
    s_add_u32 m0, s28, 3072
    s_add_u32 s30, s29, 3072
    buffer_load_dwordx4 v2, s[12:15], s30 offen lds
    s_add_u32 m0, s28, 4096
    s_add_u32 s30, s29, 4096
    buffer_load_dwordx4 v2, s[12:15], s30 offen lds
    s_add_u32 m0, s28, 5120
    s_add_u32 s30, s29, 5120
    buffer_load_dwordx4 v2, s[12:15], s30 offen lds
    s_add_u32 m0, s28, 6144
    s_add_u32 s30, s29, 6144
    buffer_load_dwordx4 v2, s[12:15], s30 offen lds
    s_add_u32 m0, s28, 7168
    s_add_u32 s30, s29, 7168
    buffer_load_dwordx4 v2, s[12:15], s30 offen lds
    s_add_u32 m0, s28, 8192
    s_add_u32 s30, s29, 8192
    buffer_load_dwordx4 v2, s[12:15], s30 offen lds
    s_add_u32 m0, s28, 9216
    s_add_u32 s30, s29, 9216
    buffer_load_dwordx4 v2, s[12:15], s30 offen lds
    s_add_u32 m0, s28, 10240
    s_add_u32 s30, s29, 10240
    buffer_load_dwordx4 v2, s[12:15], s30 offen lds
    s_add_u32 m0, s28, 11264
    s_add_u32 s30, s29, 11264
    buffer_load_dwordx4 v2, s[12:15], s30 offen lds
    s_add_u32 m0, s28, 12288
    s_add_u32 s30, s29, 12288
    buffer_load_dwordx4 v2, s[12:15], s30 offen lds
    s_add_u32 m0, s28, 13312
    s_add_u32 s30, s29, 13312
    buffer_load_dwordx4 v2, s[12:15], s30 offen lds
    s_add_u32 m0, s28, 14336
    s_add_u32 s30, s29, 14336
    buffer_load_dwordx4 v2, s[12:15], s30 offen lds
    s_add_u32 m0, s28, 15360
    s_add_u32 s30, s29, 15360
    buffer_load_dwordx4 v2, s[12:15], s30 offen lds
    s_add_u32 m0, s28, 16384
    s_add_u32 s30, s29, 16384
    buffer_load_dwordx4 v2, s[12:15], s30 offen lds
    s_add_u32 m0, s28, 17408
    s_add_u32 s30, s29, 17408
    buffer_load_dwordx4 v2, s[12:15], s30 offen lds
    s_add_u32 m0, s28, 18432
    s_add_u32 s30, s29, 18432
    buffer_load_dwordx4 v2, s[12:15], s30 offen lds
    s_add_u32 m0, s28, 19456
    s_add_u32 s30, s29, 19456
    buffer_load_dwordx4 v2, s[12:15], s30 offen lds
    s_add_u32 m0, s28, 20480
    s_add_u32 s30, s29, 20480
    buffer_load_dwordx4 v2, s[12:15], s30 offen lds
    s_add_u32 m0, s28, 21504
    s_add_u32 s30, s29, 21504
    buffer_load_dwordx4 v2, s[12:15], s30 offen lds
    s_add_u32 m0, s28, 22528
    s_add_u32 s30, s29, 22528
    buffer_load_dwordx4 v2, s[12:15], s30 offen lds
    s_add_u32 m0, s28, 23552
    s_add_u32 s30, s29, 23552
    buffer_load_dwordx4 v2, s[12:15], s30 offen lds
    s_waitcnt vmcnt(24)
    s_lshl_b32 s28, s25, 9
    s_lshl_b32 s29, s37, 2
    s_add_u32 s28, s28, s29
    s_add_u32 s28, s28, 2232320
    v_mov_b32 v2, 0
    v_mov_b32 v3, 1
    buffer_store_dword v3, v2, s[12:15], s28 offen sc0 sc1
    s_add_u32 m0, s39, 0
    s_add_u32 s44, s43, 0
    buffer_load_dwordx4 v7, s[16:19], s44 offen lds
    s_add_u32 m0, s39, 1024
    s_add_u32 s44, s43, 32768
    buffer_load_dwordx4 v8, s[16:19], s44 offen lds
    s_add_u32 m0, s39, 2048
    s_add_u32 s44, s43, 65536
    buffer_load_dwordx4 v7, s[16:19], s44 offen lds
    s_add_u32 m0, s39, 3072
    s_add_u32 s44, s43, 98304
    buffer_load_dwordx4 v8, s[16:19], s44 offen lds
    s_add_u32 m0, s39, 4096
    s_add_u32 s44, s43, 131072
    buffer_load_dwordx4 v7, s[16:19], s44 offen lds
    s_add_u32 m0, s39, 5120
    s_add_u32 s44, s43, 163840
    buffer_load_dwordx4 v8, s[16:19], s44 offen lds
    s_add_u32 m0, s39, 6144
    s_add_u32 s44, s43, 196608
    buffer_load_dwordx4 v7, s[16:19], s44 offen lds
    s_add_u32 m0, s39, 7168
    s_add_u32 s44, s43, 229376
    buffer_load_dwordx4 v8, s[16:19], s44 offen lds
    s_add_u32 s43, s43, 128
    s_min_u32 s43, s43, 896
    s_waitcnt vmcnt(9)
    s_barrier
    s_lshl_b32 s28, s25, 9
    s_lshl_b32 s29, s27, 7
    s_add_u32 s28, s28, s29
    s_add_u32 s28, s28, 2232320
    v_and_b32 v2, 31, v1
    v_lshlrev_b32 v2, 2, v2
    s_mov_b32 s36, 1048576
L_p23_kernel_pz:
    buffer_load_dword v3, v2, s[12:15], s28 offen sc0 sc1
    s_waitcnt vmcnt(0)
    v_cmp_ne_u32 vcc, 1, v3
    s_sub_u32 s36, s36, 1
    s_cbranch_vccz L_p23_kernel_pzok
    s_cmp_eq_u32 s36, 0
    s_cbranch_scc1 L_p23_kernel_pzok
    s_sleep 1
    s_branch L_p23_kernel_pz
L_p23_kernel_pzok:
    s_mul_i32 s42, s27, 917504
    s_lshl_b32 s28, s25, 12
    s_add_u32 s42, s42, s28
    s_add_u32 s42, s42, 9961472
    buffer_load_dwordx4 v[140:143], v6, s[12:15], s42 offen offset:0 sc1
    buffer_load_dwordx4 v[144:147], v6, s[12:15], s42 offen offset:1024 sc1
    buffer_load_dwordx4 v[148:151], v6, s[12:15], s42 offen offset:2048 sc1
    buffer_load_dwordx4 v[152:155], v6, s[12:15], s42 offen offset:3072 sc1
    s_add_u32 s42, s42, 28672
    buffer_load_dwordx4 v[156:159], v6, s[12:15], s42 offen offset:0 sc1
    buffer_load_dwordx4 v[160:163], v6, s[12:15], s42 offen offset:1024 sc1
    buffer_load_dwordx4 v[164:167], v6, s[12:15], s42 offen offset:2048 sc1
    buffer_load_dwordx4 v[168:171], v6, s[12:15], s42 offen offset:3072 sc1
    s_add_u32 s42, s42, 28672
    buffer_load_dwordx4 v[172:175], v6, s[12:15], s42 offen offset:0 sc1
    buffer_load_dwordx4 v[176:179], v6, s[12:15], s42 offen offset:1024 sc1
    buffer_load_dwordx4 v[180:183], v6, s[12:15], s42 offen offset:2048 sc1
    buffer_load_dwordx4 v[184:187], v6, s[12:15], s42 offen offset:3072 sc1
    s_add_u32 s42, s42, 28672
    buffer_load_dwordx4 v[188:191], v6, s[12:15], s42 offen offset:0 sc1
    buffer_load_dwordx4 v[192:195], v6, s[12:15], s42 offen offset:1024 sc1
    buffer_load_dwordx4 v[196:199], v6, s[12:15], s42 offen offset:2048 sc1
    buffer_load_dwordx4 v[200:203], v6, s[12:15], s42 offen offset:3072 sc1
    s_add_u32 s42, s42, 28672
    ds_read_b128 v[204:207], v9 offset:0
    ds_read_b128 v[208:211], v9 offset:4096
    ds_read_b128 v[212:215], v10 offset:0
    ds_read_b128 v[216:219], v10 offset:4096
    ds_read_b128 v[220:223], v11 offset:0
    ds_read_b128 v[224:227], v11 offset:4096
    ds_read_b128 v[228:231], v236 offset:0
    ds_read_b128 v[232:235], v236 offset:4096
    s_waitcnt lgkmcnt(0)
    s_add_u32 m0, s39, 0
    s_add_u32 s44, s43, 0
    buffer_load_dwordx4 v7, s[16:19], s44 offen lds
    s_add_u32 m0, s39, 1024
    s_add_u32 s44, s43, 32768
    buffer_load_dwordx4 v8, s[16:19], s44 offen lds
    s_add_u32 m0, s39, 2048
    s_add_u32 s44, s43, 65536
    buffer_load_dwordx4 v7, s[16:19], s44 offen lds
    s_add_u32 m0, s39, 3072
    s_add_u32 s44, s43, 98304
    buffer_load_dwordx4 v8, s[16:19], s44 offen lds
    s_add_u32 m0, s39, 4096
    s_add_u32 s44, s43, 131072
    buffer_load_dwordx4 v7, s[16:19], s44 offen lds
    s_add_u32 m0, s39, 5120
    s_add_u32 s44, s43, 163840
    buffer_load_dwordx4 v8, s[16:19], s44 offen lds
    s_add_u32 m0, s39, 6144
    s_add_u32 s44, s43, 196608
    buffer_load_dwordx4 v7, s[16:19], s44 offen lds
    s_add_u32 m0, s39, 7168
    s_add_u32 s44, s43, 229376
    buffer_load_dwordx4 v8, s[16:19], s44 offen lds
    s_add_u32 s43, s43, 128
    s_min_u32 s43, s43, 896
    s_mov_b32 s36, 8
    s_setprio 0
L_p23_kernel_Bl:
    s_waitcnt vmcnt(20)
    v_mfma_f32_32x32x16_bf16 v[12:27], v[140:143], v[204:207], v[12:27]
    v_mfma_f32_32x32x16_bf16 v[28:43], v[140:143], v[208:211], v[28:43]
    buffer_load_dwordx4 v[140:143], v6, s[12:15], s42 offen offset:0 sc1
    v_mfma_f32_32x32x16_bf16 v[44:59], v[144:147], v[204:207], v[44:59]
    v_mfma_f32_32x32x16_bf16 v[60:75], v[144:147], v[208:211], v[60:75]
    buffer_load_dwordx4 v[144:147], v6, s[12:15], s42 offen offset:1024 sc1
    v_mfma_f32_32x32x16_bf16 v[76:91], v[148:151], v[204:207], v[76:91]
    v_mfma_f32_32x32x16_bf16 v[92:107], v[148:151], v[208:211], v[92:107]
    buffer_load_dwordx4 v[148:151], v6, s[12:15], s42 offen offset:2048 sc1
    v_mfma_f32_32x32x16_bf16 v[108:123], v[152:155], v[204:207], v[108:123]
    v_mfma_f32_32x32x16_bf16 v[124:139], v[152:155], v[208:211], v[124:139]
    buffer_load_dwordx4 v[152:155], v6, s[12:15], s42 offen offset:3072 sc1
    s_add_u32 s42, s42, 28672
    s_waitcnt vmcnt(20)
    v_mfma_f32_32x32x16_bf16 v[12:27], v[156:159], v[212:215], v[12:27]
    v_mfma_f32_32x32x16_bf16 v[28:43], v[156:159], v[216:219], v[28:43]
    buffer_load_dwordx4 v[156:159], v6, s[12:15], s42 offen offset:0 sc1
    v_mfma_f32_32x32x16_bf16 v[44:59], v[160:163], v[212:215], v[44:59]
    v_mfma_f32_32x32x16_bf16 v[60:75], v[160:163], v[216:219], v[60:75]
    buffer_load_dwordx4 v[160:163], v6, s[12:15], s42 offen offset:1024 sc1
    v_mfma_f32_32x32x16_bf16 v[76:91], v[164:167], v[212:215], v[76:91]
    v_mfma_f32_32x32x16_bf16 v[92:107], v[164:167], v[216:219], v[92:107]
    buffer_load_dwordx4 v[164:167], v6, s[12:15], s42 offen offset:2048 sc1
    v_mfma_f32_32x32x16_bf16 v[108:123], v[168:171], v[212:215], v[108:123]
    v_mfma_f32_32x32x16_bf16 v[124:139], v[168:171], v[216:219], v[124:139]
    buffer_load_dwordx4 v[168:171], v6, s[12:15], s42 offen offset:3072 sc1
    s_add_u32 s42, s42, 28672
    s_waitcnt vmcnt(20)
    v_mfma_f32_32x32x16_bf16 v[12:27], v[172:175], v[220:223], v[12:27]
    v_mfma_f32_32x32x16_bf16 v[28:43], v[172:175], v[224:227], v[28:43]
    buffer_load_dwordx4 v[172:175], v6, s[12:15], s42 offen offset:0 sc1
    v_mfma_f32_32x32x16_bf16 v[44:59], v[176:179], v[220:223], v[44:59]
    v_mfma_f32_32x32x16_bf16 v[60:75], v[176:179], v[224:227], v[60:75]
    buffer_load_dwordx4 v[176:179], v6, s[12:15], s42 offen offset:1024 sc1
    v_mfma_f32_32x32x16_bf16 v[76:91], v[180:183], v[220:223], v[76:91]
    v_mfma_f32_32x32x16_bf16 v[92:107], v[180:183], v[224:227], v[92:107]
    buffer_load_dwordx4 v[180:183], v6, s[12:15], s42 offen offset:2048 sc1
    v_mfma_f32_32x32x16_bf16 v[108:123], v[184:187], v[220:223], v[108:123]
    v_mfma_f32_32x32x16_bf16 v[124:139], v[184:187], v[224:227], v[124:139]
    buffer_load_dwordx4 v[184:187], v6, s[12:15], s42 offen offset:3072 sc1
    s_add_u32 s42, s42, 28672
    s_waitcnt vmcnt(12)
    v_mfma_f32_32x32x16_bf16 v[12:27], v[188:191], v[228:231], v[12:27]
    v_mfma_f32_32x32x16_bf16 v[28:43], v[188:191], v[232:235], v[28:43]
    buffer_load_dwordx4 v[188:191], v6, s[12:15], s42 offen offset:0 sc1
    ds_read_b128 v[204:207], v9 offset:0
    ds_read_b128 v[208:211], v9 offset:4096
    v_mfma_f32_32x32x16_bf16 v[44:59], v[192:195], v[228:231], v[44:59]
    v_mfma_f32_32x32x16_bf16 v[60:75], v[192:195], v[232:235], v[60:75]
    buffer_load_dwordx4 v[192:195], v6, s[12:15], s42 offen offset:1024 sc1
    ds_read_b128 v[212:215], v10 offset:0
    ds_read_b128 v[216:219], v10 offset:4096
    v_mfma_f32_32x32x16_bf16 v[76:91], v[196:199], v[228:231], v[76:91]
    v_mfma_f32_32x32x16_bf16 v[92:107], v[196:199], v[232:235], v[92:107]
    buffer_load_dwordx4 v[196:199], v6, s[12:15], s42 offen offset:2048 sc1
    ds_read_b128 v[220:223], v11 offset:0
    ds_read_b128 v[224:227], v11 offset:4096
    v_mfma_f32_32x32x16_bf16 v[108:123], v[200:203], v[228:231], v[108:123]
    v_mfma_f32_32x32x16_bf16 v[124:139], v[200:203], v[232:235], v[124:139]
    buffer_load_dwordx4 v[200:203], v6, s[12:15], s42 offen offset:3072 sc1
    s_add_u32 s42, s42, 28672
    ds_read_b128 v[228:231], v236 offset:0
    ds_read_b128 v[232:235], v236 offset:4096
    s_waitcnt lgkmcnt(0)
    s_add_u32 m0, s39, 0
    s_add_u32 s44, s43, 0
    buffer_load_dwordx4 v7, s[16:19], s44 offen lds
    s_add_u32 m0, s39, 1024
    s_add_u32 s44, s43, 32768
    buffer_load_dwordx4 v8, s[16:19], s44 offen lds
    s_add_u32 m0, s39, 2048
    s_add_u32 s44, s43, 65536
    buffer_load_dwordx4 v7, s[16:19], s44 offen lds
    s_add_u32 m0, s39, 3072
    s_add_u32 s44, s43, 98304
    buffer_load_dwordx4 v8, s[16:19], s44 offen lds
    s_add_u32 m0, s39, 4096
    s_add_u32 s44, s43, 131072
    buffer_load_dwordx4 v7, s[16:19], s44 offen lds
    s_add_u32 m0, s39, 5120
    s_add_u32 s44, s43, 163840
    buffer_load_dwordx4 v8, s[16:19], s44 offen lds
    s_add_u32 m0, s39, 6144
    s_add_u32 s44, s43, 196608
    buffer_load_dwordx4 v7, s[16:19], s44 offen lds
    s_add_u32 m0, s39, 7168
    s_add_u32 s44, s43, 229376
    buffer_load_dwordx4 v8, s[16:19], s44 offen lds
    s_add_u32 s43, s43, 128
    s_min_u32 s43, s43, 896
    s_sub_u32 s36, s36, 1
    s_cmp_lg_u32 s36, 0
    s_cbranch_scc1 L_p23_kernel_Bl
    s_setprio 3
    s_waitcnt vmcnt(0)
    s_lshl_b32 s28, s24, 1
    s_mul_i32 s28, s28, 28
    s_lshl_b32 s29, s25, 2
    s_add_u32 s28, s28, s29
    s_add_u32 s28, s28, s27
    s_lshl_b32 s28, s28, 11
    s_add_u32 s28, s28, 2621440
    s_add_u32 s29, s28, 57344
    buffer_load_dwordx4 v[204:207], v6, s[12:15], s28 offen offset:0
    buffer_load_dwordx4 v[208:211], v6, s[12:15], s28 offen offset:1024
    buffer_load_dwordx4 v[212:215], v6, s[12:15], s29 offen offset:0
    buffer_load_dwordx4 v[216:219], v6, s[12:15], s29 offen offset:1024
    s_lshl_b32 s28, s24, 10
    s_add_u32 s28, s28, 2237312
    v_and_b32 v3, 3, v1
    v_lshlrev_b32 v3, 2, v3
    buffer_load_dword v225, v3, s[12:15], s28 offen sc0 sc1
    v_lshlrev_b32 v2, 4, v1
    s_mul_i32 s46, s27, 229376
    s_lshl_b32 s47, s27, 17
    s_and_b32 s28, s27, 1
    s_mul_i32 s45, s28, 24576
    s_lshr_b32 s28, s27, 1
    s_lshl_b32 s28, s28, 16
    s_add_u32 s45, s45, s28
    v_lshrrev_b32 v7, 3, v1
    v_lshlrev_b32 v7, 10, v7
    v_bfe_u32 v3, v1, 4, 1
    v_lshlrev_b32 v3, 2, v3
    v_xor_b32 v3, v3, v1
    v_and_b32 v3, 7, v3
    v_lshlrev_b32 v3, 4, v3
    v_add_u32 v7, v7, v3
    s_lshl_b32 s28, s25, 7
    v_add_u32 v7, s28, v7
    s_add_u32 m0, s39, 0
    s_add_u32 s30, s46, 196608
    buffer_load_dwordx4 v7, s[60:63], s30 offen lds
    s_add_u32 m0, s39, 1024
    s_add_u32 s30, s46, 204800
    buffer_load_dwordx4 v7, s[60:63], s30 offen lds
    s_add_u32 m0, s39, 2048
    s_add_u32 s30, s46, 212992
    buffer_load_dwordx4 v7, s[60:63], s30 offen lds
    s_add_u32 m0, s39, 3072
    s_add_u32 s30, s46, 221184
    buffer_load_dwordx4 v7, s[60:63], s30 offen lds
    s_add_u32 m0, s39, 4096
    s_add_u32 s30, s47, 0
    buffer_load_dwordx4 v7, s[56:59], s30 offen lds
    s_add_u32 m0, s39, 5120
    s_add_u32 s30, s47, 8192
    buffer_load_dwordx4 v7, s[56:59], s30 offen lds
    s_add_u32 m0, s39, 6144
    s_add_u32 s30, s47, 16384
    buffer_load_dwordx4 v7, s[56:59], s30 offen lds
    s_add_u32 m0, s39, 7168
    s_add_u32 s30, s47, 24576
    buffer_load_dwordx4 v7, s[56:59], s30 offen lds
    s_barrier
    s_cmp_eq_u32 s27, 0
    s_cbranch_scc0 L_p23_kernel_Bs0
    v_add_u32 v3, 40960, v2
    ds_write_b128 v3, v[44:47] offset:0
    ds_write_b128 v3, v[48:51] offset:1024
    ds_write_b128 v3, v[52:55] offset:2048
    ds_write_b128 v3, v[56:59] offset:3072
    ds_write_b128 v3, v[60:63] offset:4096
    ds_write_b128 v3, v[64:67] offset:5120
    ds_write_b128 v3, v[68:71] offset:6144
    ds_write_b128 v3, v[72:75] offset:7168
    v_add_u32 v3, 73728, v2
    ds_write_b128 v3, v[76:79] offset:0
    ds_write_b128 v3, v[80:83] offset:1024
    ds_write_b128 v3, v[84:87] offset:2048
    ds_write_b128 v3, v[88:91] offset:3072
    ds_write_b128 v3, v[92:95] offset:4096
    ds_write_b128 v3, v[96:99] offset:5120
    ds_write_b128 v3, v[100:103] offset:6144
    ds_write_b128 v3, v[104:107] offset:7168
    v_add_u32 v3, 90112, v2
    ds_write_b128 v3, v[108:111] offset:0
    ds_write_b128 v3, v[112:115] offset:1024
    ds_write_b128 v3, v[116:119] offset:2048
    ds_write_b128 v3, v[120:123] offset:3072
    ds_write_b128 v3, v[124:127] offset:4096
    ds_write_b128 v3, v[128:131] offset:5120
    ds_write_b128 v3, v[132:135] offset:6144
    ds_write_b128 v3, v[136:139] offset:7168
    s_waitcnt lgkmcnt(0)
    v_mov_b32 v4, 49152
    v_mov_b32 v5, 2143387585
    ds_write_b32 v4, v5
    v_and_b32 v4, 3, v1
    v_lshlrev_b32 v4, 2, v4
    v_add_u32 v4, 49152, v4
    s_mov_b32 s36, 1048576
    s_mov_b32 s28, 2143387585
L_p23_kernel_hs0:
    ds_read_b32 v3, v4
    s_waitcnt lgkmcnt(0)
    v_cmp_ne_u32 vcc, s28, v3
    s_sub_u32 s36, s36, 1
    s_cbranch_vccz L_p23_kernel_hs0ok
    s_cmp_eq_u32 s36, 0
    s_cbranch_scc0 L_p23_kernel_hs0
L_p23_kernel_hs0ok:
    v_mov_b32 v3, v2
    ds_read_b128 v[140:143], v3 offset:0
    ds_read_b128 v[144:147], v3 offset:1024
    ds_read_b128 v[148:151], v3 offset:2048
    ds_read_b128 v[152:155], v3 offset:3072
    ds_read_b128 v[156:159], v3 offset:8192
    ds_read_b128 v[160:163], v3 offset:9216
    ds_read_b128 v[164:167], v3 offset:10240
    ds_read_b128 v[168:171], v3 offset:11264
    ds_read_b128 v[172:175], v3 offset:16384
    ds_read_b128 v[176:179], v3 offset:17408
    ds_read_b128 v[180:183], v3 offset:18432
    ds_read_b128 v[184:187], v3 offset:19456
    s_waitcnt lgkmcnt(0)
    ds_read_b128 v[44:47], v3 offset:4096
    ds_read_b128 v[48:51], v3 offset:5120
    ds_read_b128 v[52:55], v3 offset:6144
    ds_read_b128 v[56:59], v3 offset:7168
    ds_read_b128 v[60:63], v3 offset:12288
    ds_read_b128 v[64:67], v3 offset:13312
    ds_read_b128 v[68:71], v3 offset:14336
    ds_read_b128 v[72:75], v3 offset:15360
    ds_read_b128 v[76:79], v3 offset:20480
    ds_read_b128 v[80:83], v3 offset:21504
    ds_read_b128 v[84:87], v3 offset:22528
    ds_read_b128 v[88:91], v3 offset:23552
    s_waitcnt lgkmcnt(0) vmcnt(0)
    v_add_f32 v12, v12, v140
    v_add_f32 v13, v13, v141
    v_add_f32 v14, v14, v142
    v_add_f32 v15, v15, v143
    v_add_f32 v16, v16, v144
    v_add_f32 v17, v17, v145
    v_add_f32 v18, v18, v146
    v_add_f32 v19, v19, v147
    v_add_f32 v20, v20, v148
    v_add_f32 v21, v21, v149
    v_add_f32 v22, v22, v150
    v_add_f32 v23, v23, v151
    v_add_f32 v24, v24, v152
    v_add_f32 v25, v25, v153
    v_add_f32 v26, v26, v154
    v_add_f32 v27, v27, v155
    s_add_u32 m0, s45, 0
    s_add_u32 s30, s46, 0
    buffer_load_dwordx4 v7, s[60:63], s30 offen lds
    s_add_u32 m0, s45, 1024
    s_add_u32 s30, s46, 8192
    buffer_load_dwordx4 v7, s[60:63], s30 offen lds
    v_add_f32 v12, v12, v156
    v_add_f32 v13, v13, v157
    v_add_f32 v14, v14, v158
    v_add_f32 v15, v15, v159
    v_add_f32 v16, v16, v160
    v_add_f32 v17, v17, v161
    v_add_f32 v18, v18, v162
    v_add_f32 v19, v19, v163
    v_add_f32 v20, v20, v164
    v_add_f32 v21, v21, v165
    v_add_f32 v22, v22, v166
    v_add_f32 v23, v23, v167
    v_add_f32 v24, v24, v168
    v_add_f32 v25, v25, v169
    v_add_f32 v26, v26, v170
    v_add_f32 v27, v27, v171
    s_add_u32 m0, s45, 2048
    s_add_u32 s30, s46, 16384
    buffer_load_dwordx4 v7, s[60:63], s30 offen lds
    s_add_u32 m0, s45, 3072
    s_add_u32 s30, s46, 24576
    buffer_load_dwordx4 v7, s[60:63], s30 offen lds
    v_add_f32 v12, v12, v172
    v_add_f32 v13, v13, v173
    v_add_f32 v14, v14, v174
    v_add_f32 v15, v15, v175
    v_add_f32 v16, v16, v176
    v_add_f32 v17, v17, v177
    v_add_f32 v18, v18, v178
    v_add_f32 v19, v19, v179
    v_add_f32 v20, v20, v180
    v_add_f32 v21, v21, v181
    v_add_f32 v22, v22, v182
    v_add_f32 v23, v23, v183
    v_add_f32 v24, v24, v184
    v_add_f32 v25, v25, v185
    v_add_f32 v26, v26, v186
    v_add_f32 v27, v27, v187
    s_add_u32 m0, s45, 4096
    s_add_u32 s30, s46, 32768
    buffer_load_dwordx4 v7, s[60:63], s30 offen lds
    s_add_u32 m0, s45, 5120
    s_add_u32 s30, s46, 40960
    buffer_load_dwordx4 v7, s[60:63], s30 offen lds
    v_lshlrev_b32 v92, 16, v204
    v_and_b32 v93, 0xffff0000, v204
    v_mul_f32 v92, v92, v12
    v_mul_f32 v93, v93, v13
    v_cvt_pk_bf16_f32 v204, v92, v93
    v_lshlrev_b32 v92, 16, v205
    v_and_b32 v93, 0xffff0000, v205
    v_mul_f32 v92, v92, v14
    v_mul_f32 v93, v93, v15
    v_cvt_pk_bf16_f32 v205, v92, v93
    v_lshlrev_b32 v92, 16, v206
    v_and_b32 v93, 0xffff0000, v206
    v_mul_f32 v92, v92, v16
    v_mul_f32 v93, v93, v17
    v_cvt_pk_bf16_f32 v206, v92, v93
    s_add_u32 m0, s45, 6144
    s_add_u32 s30, s46, 49152
    buffer_load_dwordx4 v7, s[60:63], s30 offen lds
    s_add_u32 m0, s45, 7168
    s_add_u32 s30, s46, 57344
    buffer_load_dwordx4 v7, s[60:63], s30 offen lds
    v_lshlrev_b32 v92, 16, v207
    v_and_b32 v93, 0xffff0000, v207
    v_mul_f32 v92, v92, v18
    v_mul_f32 v93, v93, v19
    v_cvt_pk_bf16_f32 v207, v92, v93
    v_lshlrev_b32 v92, 16, v208
    v_and_b32 v93, 0xffff0000, v208
    v_mul_f32 v92, v92, v20
    v_mul_f32 v93, v93, v21
    v_cvt_pk_bf16_f32 v208, v92, v93
    s_add_u32 m0, s45, 8192
    s_add_u32 s30, s46, 65536
    buffer_load_dwordx4 v7, s[60:63], s30 offen lds
    s_add_u32 m0, s45, 9216
    s_add_u32 s30, s46, 73728
    buffer_load_dwordx4 v7, s[60:63], s30 offen lds
    v_lshlrev_b32 v92, 16, v209
    v_and_b32 v93, 0xffff0000, v209
    v_mul_f32 v92, v92, v22
    v_mul_f32 v93, v93, v23
    v_cvt_pk_bf16_f32 v209, v92, v93
    v_lshlrev_b32 v92, 16, v210
    v_and_b32 v93, 0xffff0000, v210
    v_mul_f32 v92, v92, v24
    v_mul_f32 v93, v93, v25
    v_cvt_pk_bf16_f32 v210, v92, v93
    s_add_u32 m0, s45, 10240
    s_add_u32 s30, s46, 81920
    buffer_load_dwordx4 v7, s[60:63], s30 offen lds
    s_add_u32 m0, s45, 11264
    s_add_u32 s30, s46, 90112
    buffer_load_dwordx4 v7, s[60:63], s30 offen lds
    v_lshlrev_b32 v92, 16, v211
    v_and_b32 v93, 0xffff0000, v211
    v_mul_f32 v92, v92, v26
    v_mul_f32 v93, v93, v27
    v_cvt_pk_bf16_f32 v211, v92, v93
    v_add_f32 v28, v28, v44
    v_add_f32 v29, v29, v45
    v_add_f32 v30, v30, v46
    v_add_f32 v31, v31, v47
    v_add_f32 v32, v32, v48
    v_add_f32 v33, v33, v49
    v_add_f32 v34, v34, v50
    v_add_f32 v35, v35, v51
    v_add_f32 v36, v36, v52
    v_add_f32 v37, v37, v53
    v_add_f32 v38, v38, v54
    v_add_f32 v39, v39, v55
    v_add_f32 v40, v40, v56
    v_add_f32 v41, v41, v57
    v_add_f32 v42, v42, v58
    v_add_f32 v43, v43, v59
    s_add_u32 m0, s45, 12288
    s_add_u32 s30, s46, 98304
    buffer_load_dwordx4 v7, s[60:63], s30 offen lds
    s_add_u32 m0, s45, 13312
    s_add_u32 s30, s46, 106496
    buffer_load_dwordx4 v7, s[60:63], s30 offen lds
    v_add_f32 v28, v28, v60
    v_add_f32 v29, v29, v61
    v_add_f32 v30, v30, v62
    v_add_f32 v31, v31, v63
    v_add_f32 v32, v32, v64
    v_add_f32 v33, v33, v65
    v_add_f32 v34, v34, v66
    v_add_f32 v35, v35, v67
    v_add_f32 v36, v36, v68
    v_add_f32 v37, v37, v69
    v_add_f32 v38, v38, v70
    v_add_f32 v39, v39, v71
    v_add_f32 v40, v40, v72
    v_add_f32 v41, v41, v73
    v_add_f32 v42, v42, v74
    v_add_f32 v43, v43, v75
    s_add_u32 m0, s45, 14336
    s_add_u32 s30, s46, 114688
    buffer_load_dwordx4 v7, s[60:63], s30 offen lds
    s_add_u32 m0, s45, 15360
    s_add_u32 s30, s46, 122880
    buffer_load_dwordx4 v7, s[60:63], s30 offen lds
    v_add_f32 v28, v28, v76
    v_add_f32 v29, v29, v77
    v_add_f32 v30, v30, v78
    v_add_f32 v31, v31, v79
    v_add_f32 v32, v32, v80
    v_add_f32 v33, v33, v81
    v_add_f32 v34, v34, v82
    v_add_f32 v35, v35, v83
    v_add_f32 v36, v36, v84
    v_add_f32 v37, v37, v85
    v_add_f32 v38, v38, v86
    v_add_f32 v39, v39, v87
    v_add_f32 v40, v40, v88
    v_add_f32 v41, v41, v89
    v_add_f32 v42, v42, v90
    v_add_f32 v43, v43, v91
    s_add_u32 m0, s45, 16384
    s_add_u32 s30, s46, 131072
    buffer_load_dwordx4 v7, s[60:63], s30 offen lds
    s_add_u32 m0, s45, 17408
    s_add_u32 s30, s46, 139264
    buffer_load_dwordx4 v7, s[60:63], s30 offen lds
    v_lshlrev_b32 v92, 16, v212
    v_and_b32 v93, 0xffff0000, v212
    v_mul_f32 v92, v92, v28
    v_mul_f32 v93, v93, v29
    v_cvt_pk_bf16_f32 v212, v92, v93
    v_lshlrev_b32 v92, 16, v213
    v_and_b32 v93, 0xffff0000, v213
    v_mul_f32 v92, v92, v30
    v_mul_f32 v93, v93, v31
    v_cvt_pk_bf16_f32 v213, v92, v93
    v_lshlrev_b32 v92, 16, v214
    v_and_b32 v93, 0xffff0000, v214
    v_mul_f32 v92, v92, v32
    v_mul_f32 v93, v93, v33
    v_cvt_pk_bf16_f32 v214, v92, v93
    s_add_u32 m0, s45, 18432
    s_add_u32 s30, s46, 147456
    buffer_load_dwordx4 v7, s[60:63], s30 offen lds
    s_add_u32 m0, s45, 19456
    s_add_u32 s30, s46, 155648
    buffer_load_dwordx4 v7, s[60:63], s30 offen lds
    v_lshlrev_b32 v92, 16, v215
    v_and_b32 v93, 0xffff0000, v215
    v_mul_f32 v92, v92, v34
    v_mul_f32 v93, v93, v35
    v_cvt_pk_bf16_f32 v215, v92, v93
    v_lshlrev_b32 v92, 16, v216
    v_and_b32 v93, 0xffff0000, v216
    v_mul_f32 v92, v92, v36
    v_mul_f32 v93, v93, v37
    v_cvt_pk_bf16_f32 v216, v92, v93
    s_add_u32 m0, s45, 20480
    s_add_u32 s30, s46, 163840
    buffer_load_dwordx4 v7, s[60:63], s30 offen lds
    s_add_u32 m0, s45, 21504
    s_add_u32 s30, s46, 172032
    buffer_load_dwordx4 v7, s[60:63], s30 offen lds
    v_lshlrev_b32 v92, 16, v217
    v_and_b32 v93, 0xffff0000, v217
    v_mul_f32 v92, v92, v38
    v_mul_f32 v93, v93, v39
    v_cvt_pk_bf16_f32 v217, v92, v93
    v_lshlrev_b32 v92, 16, v218
    v_and_b32 v93, 0xffff0000, v218
    v_mul_f32 v92, v92, v40
    v_mul_f32 v93, v93, v41
    v_cvt_pk_bf16_f32 v218, v92, v93
    s_add_u32 m0, s45, 22528
    s_add_u32 s30, s46, 180224
    buffer_load_dwordx4 v7, s[60:63], s30 offen lds
    s_add_u32 m0, s45, 23552
    s_add_u32 s30, s46, 188416
    buffer_load_dwordx4 v7, s[60:63], s30 offen lds
    v_lshlrev_b32 v92, 16, v219
    v_and_b32 v93, 0xffff0000, v219
    v_mul_f32 v92, v92, v42
    v_mul_f32 v93, v93, v43
    v_cvt_pk_bf16_f32 v219, v92, v93
    v_cmp_ne_u32 vcc, 1, v225
    s_cbranch_vccz L_p23_kernel_mkb0done
    s_lshl_b32 s28, s24, 10
    s_add_u32 s28, s28, 2237312
    v_and_b32 v4, 3, v1
    v_lshlrev_b32 v4, 2, v4
    s_mov_b32 s29, s28
    s_mov_b32 s36, 1048576
L_p23_kernel_mkb0:
    buffer_load_dword v3, v4, s[12:15], s29 offen sc0 sc1
    s_waitcnt vmcnt(0)
    v_cmp_ne_u32 vcc, 1, v3
    s_sub_u32 s36, s36, 1
    s_cbranch_vccz L_p23_kernel_mkb0ok
    s_cmp_eq_u32 s36, 0
    s_cbranch_scc1 L_p23_kernel_mkb0ok
    s_sleep 1
    s_branch L_p23_kernel_mkb0
L_p23_kernel_mkb0ok:
L_p23_kernel_mkb0done:
    s_lshl_b32 s28, s24, 1
    s_add_u32 s28, s28, 0
    s_mul_i32 s28, s28, 88
    s_lshl_b32 s29, s25, 3
    s_add_u32 s28, s28, s29
    s_add_u32 s28, s28, 32
    s_lshl_b32 s28, s28, 10
    s_add_u32 s28, s28, 13631488
    buffer_store_dwordx4 v[204:207], v6, s[12:15], s28 offen offset:0 sc0 sc1
    buffer_store_dwordx4 v[208:211], v6, s[12:15], s28 offen offset:1024 sc0 sc1
    s_lshl_b32 s28, s24, 1
    s_add_u32 s28, s28, 1
    s_mul_i32 s28, s28, 88
    s_lshl_b32 s29, s25, 3
    s_add_u32 s28, s28, s29
    s_add_u32 s28, s28, 32
    s_lshl_b32 s28, s28, 10
    s_add_u32 s28, s28, 13631488
    buffer_store_dwordx4 v[212:215], v6, s[12:15], s28 offen offset:0 sc0 sc1
    buffer_store_dwordx4 v[216:219], v6, s[12:15], s28 offen offset:1024 sc0 sc1
    s_branch L_p23_kernel_P3
L_p23_kernel_Bs0:
    s_cmp_eq_u32 s27, 1
    s_cbranch_scc0 L_p23_kernel_Bs1
    v_mov_b32 v3, v2
    ds_write_b128 v3, v[12:15] offset:0
    ds_write_b128 v3, v[16:19] offset:1024
    ds_write_b128 v3, v[20:23] offset:2048
    ds_write_b128 v3, v[24:27] offset:3072
    ds_write_b128 v3, v[28:31] offset:4096
    ds_write_b128 v3, v[32:35] offset:5120
    ds_write_b128 v3, v[36:39] offset:6144
    ds_write_b128 v3, v[40:43] offset:7168
    v_add_u32 v3, 81920, v2
    ds_write_b128 v3, v[76:79] offset:0
    ds_write_b128 v3, v[80:83] offset:1024
    ds_write_b128 v3, v[84:87] offset:2048
    ds_write_b128 v3, v[88:91] offset:3072
    ds_write_b128 v3, v[92:95] offset:4096
    ds_write_b128 v3, v[96:99] offset:5120
    ds_write_b128 v3, v[100:103] offset:6144
    ds_write_b128 v3, v[104:107] offset:7168
    v_add_u32 v3, 98304, v2
    ds_write_b128 v3, v[108:111] offset:0
    ds_write_b128 v3, v[112:115] offset:1024
    ds_write_b128 v3, v[116:119] offset:2048
    ds_write_b128 v3, v[120:123] offset:3072
    ds_write_b128 v3, v[124:127] offset:4096
    ds_write_b128 v3, v[128:131] offset:5120
    ds_write_b128 v3, v[132:135] offset:6144
    ds_write_b128 v3, v[136:139] offset:7168
    s_waitcnt lgkmcnt(0)
    v_mov_b32 v4, 49156
    v_mov_b32 v5, 2143387585
    ds_write_b32 v4, v5
    v_and_b32 v4, 3, v1
    v_lshlrev_b32 v4, 2, v4
    v_add_u32 v4, 49152, v4
    s_mov_b32 s36, 1048576
    s_mov_b32 s28, 2143387585
L_p23_kernel_hs1:
    ds_read_b32 v3, v4
    s_waitcnt lgkmcnt(0)
    v_cmp_ne_u32 vcc, s28, v3
    s_sub_u32 s36, s36, 1
    s_cbranch_vccz L_p23_kernel_hs1ok
    s_cmp_eq_u32 s36, 0
    s_cbranch_scc0 L_p23_kernel_hs1
L_p23_kernel_hs1ok:
    v_add_u32 v3, 24576, v2
    ds_read_b128 v[140:143], v3 offset:0
    ds_read_b128 v[144:147], v3 offset:1024
    ds_read_b128 v[148:151], v3 offset:2048
    ds_read_b128 v[152:155], v3 offset:3072
    ds_read_b128 v[156:159], v3 offset:8192
    ds_read_b128 v[160:163], v3 offset:9216
    ds_read_b128 v[164:167], v3 offset:10240
    ds_read_b128 v[168:171], v3 offset:11264
    ds_read_b128 v[172:175], v3 offset:16384
    ds_read_b128 v[176:179], v3 offset:17408
    ds_read_b128 v[180:183], v3 offset:18432
    ds_read_b128 v[184:187], v3 offset:19456
    s_waitcnt lgkmcnt(0)
    ds_read_b128 v[12:15], v3 offset:4096
    ds_read_b128 v[16:19], v3 offset:5120
    ds_read_b128 v[20:23], v3 offset:6144
    ds_read_b128 v[24:27], v3 offset:7168
    ds_read_b128 v[28:31], v3 offset:12288
    ds_read_b128 v[32:35], v3 offset:13312
    ds_read_b128 v[36:39], v3 offset:14336
    ds_read_b128 v[40:43], v3 offset:15360
    ds_read_b128 v[76:79], v3 offset:20480
    ds_read_b128 v[80:83], v3 offset:21504
    ds_read_b128 v[84:87], v3 offset:22528
    ds_read_b128 v[88:91], v3 offset:23552
    s_waitcnt lgkmcnt(0) vmcnt(0)
    v_add_f32 v44, v44, v140
    v_add_f32 v45, v45, v141
    v_add_f32 v46, v46, v142
    v_add_f32 v47, v47, v143
    v_add_f32 v48, v48, v144
    v_add_f32 v49, v49, v145
    v_add_f32 v50, v50, v146
    v_add_f32 v51, v51, v147
    v_add_f32 v52, v52, v148
    v_add_f32 v53, v53, v149
    v_add_f32 v54, v54, v150
    v_add_f32 v55, v55, v151
    v_add_f32 v56, v56, v152
    v_add_f32 v57, v57, v153
    v_add_f32 v58, v58, v154
    v_add_f32 v59, v59, v155
    s_add_u32 m0, s45, 0
    s_add_u32 s30, s46, 0
    buffer_load_dwordx4 v7, s[60:63], s30 offen lds
    s_add_u32 m0, s45, 1024
    s_add_u32 s30, s46, 8192
    buffer_load_dwordx4 v7, s[60:63], s30 offen lds
    v_add_f32 v44, v44, v156
    v_add_f32 v45, v45, v157
    v_add_f32 v46, v46, v158
    v_add_f32 v47, v47, v159
    v_add_f32 v48, v48, v160
    v_add_f32 v49, v49, v161
    v_add_f32 v50, v50, v162
    v_add_f32 v51, v51, v163
    v_add_f32 v52, v52, v164
    v_add_f32 v53, v53, v165
    v_add_f32 v54, v54, v166
    v_add_f32 v55, v55, v167
    v_add_f32 v56, v56, v168
    v_add_f32 v57, v57, v169
    v_add_f32 v58, v58, v170
    v_add_f32 v59, v59, v171
    s_add_u32 m0, s45, 2048
    s_add_u32 s30, s46, 16384
    buffer_load_dwordx4 v7, s[60:63], s30 offen lds
    s_add_u32 m0, s45, 3072
    s_add_u32 s30, s46, 24576
    buffer_load_dwordx4 v7, s[60:63], s30 offen lds
    v_add_f32 v44, v44, v172
    v_add_f32 v45, v45, v173
    v_add_f32 v46, v46, v174
    v_add_f32 v47, v47, v175
    v_add_f32 v48, v48, v176
    v_add_f32 v49, v49, v177
    v_add_f32 v50, v50, v178
    v_add_f32 v51, v51, v179
    v_add_f32 v52, v52, v180
    v_add_f32 v53, v53, v181
    v_add_f32 v54, v54, v182
    v_add_f32 v55, v55, v183
    v_add_f32 v56, v56, v184
    v_add_f32 v57, v57, v185
    v_add_f32 v58, v58, v186
    v_add_f32 v59, v59, v187
    s_add_u32 m0, s45, 4096
    s_add_u32 s30, s46, 32768
    buffer_load_dwordx4 v7, s[60:63], s30 offen lds
    s_add_u32 m0, s45, 5120
    s_add_u32 s30, s46, 40960
    buffer_load_dwordx4 v7, s[60:63], s30 offen lds
    v_lshlrev_b32 v92, 16, v204
    v_and_b32 v93, 0xffff0000, v204
    v_mul_f32 v92, v92, v44
    v_mul_f32 v93, v93, v45
    v_cvt_pk_bf16_f32 v204, v92, v93
    v_lshlrev_b32 v92, 16, v205
    v_and_b32 v93, 0xffff0000, v205
    v_mul_f32 v92, v92, v46
    v_mul_f32 v93, v93, v47
    v_cvt_pk_bf16_f32 v205, v92, v93
    v_lshlrev_b32 v92, 16, v206
    v_and_b32 v93, 0xffff0000, v206
    v_mul_f32 v92, v92, v48
    v_mul_f32 v93, v93, v49
    v_cvt_pk_bf16_f32 v206, v92, v93
    s_add_u32 m0, s45, 6144
    s_add_u32 s30, s46, 49152
    buffer_load_dwordx4 v7, s[60:63], s30 offen lds
    s_add_u32 m0, s45, 7168
    s_add_u32 s30, s46, 57344
    buffer_load_dwordx4 v7, s[60:63], s30 offen lds
    v_lshlrev_b32 v92, 16, v207
    v_and_b32 v93, 0xffff0000, v207
    v_mul_f32 v92, v92, v50
    v_mul_f32 v93, v93, v51
    v_cvt_pk_bf16_f32 v207, v92, v93
    v_lshlrev_b32 v92, 16, v208
    v_and_b32 v93, 0xffff0000, v208
    v_mul_f32 v92, v92, v52
    v_mul_f32 v93, v93, v53
    v_cvt_pk_bf16_f32 v208, v92, v93
    s_add_u32 m0, s45, 8192
    s_add_u32 s30, s46, 65536
    buffer_load_dwordx4 v7, s[60:63], s30 offen lds
    s_add_u32 m0, s45, 9216
    s_add_u32 s30, s46, 73728
    buffer_load_dwordx4 v7, s[60:63], s30 offen lds
    v_lshlrev_b32 v92, 16, v209
    v_and_b32 v93, 0xffff0000, v209
    v_mul_f32 v92, v92, v54
    v_mul_f32 v93, v93, v55
    v_cvt_pk_bf16_f32 v209, v92, v93
    v_lshlrev_b32 v92, 16, v210
    v_and_b32 v93, 0xffff0000, v210
    v_mul_f32 v92, v92, v56
    v_mul_f32 v93, v93, v57
    v_cvt_pk_bf16_f32 v210, v92, v93
    s_add_u32 m0, s45, 10240
    s_add_u32 s30, s46, 81920
    buffer_load_dwordx4 v7, s[60:63], s30 offen lds
    s_add_u32 m0, s45, 11264
    s_add_u32 s30, s46, 90112
    buffer_load_dwordx4 v7, s[60:63], s30 offen lds
    v_lshlrev_b32 v92, 16, v211
    v_and_b32 v93, 0xffff0000, v211
    v_mul_f32 v92, v92, v58
    v_mul_f32 v93, v93, v59
    v_cvt_pk_bf16_f32 v211, v92, v93
    v_add_f32 v60, v60, v12
    v_add_f32 v61, v61, v13
    v_add_f32 v62, v62, v14
    v_add_f32 v63, v63, v15
    v_add_f32 v64, v64, v16
    v_add_f32 v65, v65, v17
    v_add_f32 v66, v66, v18
    v_add_f32 v67, v67, v19
    v_add_f32 v68, v68, v20
    v_add_f32 v69, v69, v21
    v_add_f32 v70, v70, v22
    v_add_f32 v71, v71, v23
    v_add_f32 v72, v72, v24
    v_add_f32 v73, v73, v25
    v_add_f32 v74, v74, v26
    v_add_f32 v75, v75, v27
    s_add_u32 m0, s45, 12288
    s_add_u32 s30, s46, 98304
    buffer_load_dwordx4 v7, s[60:63], s30 offen lds
    s_add_u32 m0, s45, 13312
    s_add_u32 s30, s46, 106496
    buffer_load_dwordx4 v7, s[60:63], s30 offen lds
    v_add_f32 v60, v60, v28
    v_add_f32 v61, v61, v29
    v_add_f32 v62, v62, v30
    v_add_f32 v63, v63, v31
    v_add_f32 v64, v64, v32
    v_add_f32 v65, v65, v33
    v_add_f32 v66, v66, v34
    v_add_f32 v67, v67, v35
    v_add_f32 v68, v68, v36
    v_add_f32 v69, v69, v37
    v_add_f32 v70, v70, v38
    v_add_f32 v71, v71, v39
    v_add_f32 v72, v72, v40
    v_add_f32 v73, v73, v41
    v_add_f32 v74, v74, v42
    v_add_f32 v75, v75, v43
    s_add_u32 m0, s45, 14336
    s_add_u32 s30, s46, 114688
    buffer_load_dwordx4 v7, s[60:63], s30 offen lds
    s_add_u32 m0, s45, 15360
    s_add_u32 s30, s46, 122880
    buffer_load_dwordx4 v7, s[60:63], s30 offen lds
    v_add_f32 v60, v60, v76
    v_add_f32 v61, v61, v77
    v_add_f32 v62, v62, v78
    v_add_f32 v63, v63, v79
    v_add_f32 v64, v64, v80
    v_add_f32 v65, v65, v81
    v_add_f32 v66, v66, v82
    v_add_f32 v67, v67, v83
    v_add_f32 v68, v68, v84
    v_add_f32 v69, v69, v85
    v_add_f32 v70, v70, v86
    v_add_f32 v71, v71, v87
    v_add_f32 v72, v72, v88
    v_add_f32 v73, v73, v89
    v_add_f32 v74, v74, v90
    v_add_f32 v75, v75, v91
    s_add_u32 m0, s45, 16384
    s_add_u32 s30, s46, 131072
    buffer_load_dwordx4 v7, s[60:63], s30 offen lds
    s_add_u32 m0, s45, 17408
    s_add_u32 s30, s46, 139264
    buffer_load_dwordx4 v7, s[60:63], s30 offen lds
    v_lshlrev_b32 v92, 16, v212
    v_and_b32 v93, 0xffff0000, v212
    v_mul_f32 v92, v92, v60
    v_mul_f32 v93, v93, v61
    v_cvt_pk_bf16_f32 v212, v92, v93
    v_lshlrev_b32 v92, 16, v213
    v_and_b32 v93, 0xffff0000, v213
    v_mul_f32 v92, v92, v62
    v_mul_f32 v93, v93, v63
    v_cvt_pk_bf16_f32 v213, v92, v93
    v_lshlrev_b32 v92, 16, v214
    v_and_b32 v93, 0xffff0000, v214
    v_mul_f32 v92, v92, v64
    v_mul_f32 v93, v93, v65
    v_cvt_pk_bf16_f32 v214, v92, v93
    s_add_u32 m0, s45, 18432
    s_add_u32 s30, s46, 147456
    buffer_load_dwordx4 v7, s[60:63], s30 offen lds
    s_add_u32 m0, s45, 19456
    s_add_u32 s30, s46, 155648
    buffer_load_dwordx4 v7, s[60:63], s30 offen lds
    v_lshlrev_b32 v92, 16, v215
    v_and_b32 v93, 0xffff0000, v215
    v_mul_f32 v92, v92, v66
    v_mul_f32 v93, v93, v67
    v_cvt_pk_bf16_f32 v215, v92, v93
    v_lshlrev_b32 v92, 16, v216
    v_and_b32 v93, 0xffff0000, v216
    v_mul_f32 v92, v92, v68
    v_mul_f32 v93, v93, v69
    v_cvt_pk_bf16_f32 v216, v92, v93
    s_add_u32 m0, s45, 20480
    s_add_u32 s30, s46, 163840
    buffer_load_dwordx4 v7, s[60:63], s30 offen lds
    s_add_u32 m0, s45, 21504
    s_add_u32 s30, s46, 172032
    buffer_load_dwordx4 v7, s[60:63], s30 offen lds
    v_lshlrev_b32 v92, 16, v217
    v_and_b32 v93, 0xffff0000, v217
    v_mul_f32 v92, v92, v70
    v_mul_f32 v93, v93, v71
    v_cvt_pk_bf16_f32 v217, v92, v93
    v_lshlrev_b32 v92, 16, v218
    v_and_b32 v93, 0xffff0000, v218
    v_mul_f32 v92, v92, v72
    v_mul_f32 v93, v93, v73
    v_cvt_pk_bf16_f32 v218, v92, v93
    s_add_u32 m0, s45, 22528
    s_add_u32 s30, s46, 180224
    buffer_load_dwordx4 v7, s[60:63], s30 offen lds
    s_add_u32 m0, s45, 23552
    s_add_u32 s30, s46, 188416
    buffer_load_dwordx4 v7, s[60:63], s30 offen lds
    v_lshlrev_b32 v92, 16, v219
    v_and_b32 v93, 0xffff0000, v219
    v_mul_f32 v92, v92, v74
    v_mul_f32 v93, v93, v75
    v_cvt_pk_bf16_f32 v219, v92, v93
    v_cmp_ne_u32 vcc, 1, v225
    s_cbranch_vccz L_p23_kernel_mkb1done
    s_lshl_b32 s28, s24, 10
    s_add_u32 s28, s28, 2237312
    v_and_b32 v4, 3, v1
    v_lshlrev_b32 v4, 2, v4
    s_mov_b32 s29, s28
    s_mov_b32 s36, 1048576
L_p23_kernel_mkb1:
    buffer_load_dword v3, v4, s[12:15], s29 offen sc0 sc1
    s_waitcnt vmcnt(0)
    v_cmp_ne_u32 vcc, 1, v3
    s_sub_u32 s36, s36, 1
    s_cbranch_vccz L_p23_kernel_mkb1ok
    s_cmp_eq_u32 s36, 0
    s_cbranch_scc1 L_p23_kernel_mkb1ok
    s_sleep 1
    s_branch L_p23_kernel_mkb1
L_p23_kernel_mkb1ok:
L_p23_kernel_mkb1done:
    s_lshl_b32 s28, s24, 1
    s_add_u32 s28, s28, 0
    s_mul_i32 s28, s28, 88
    s_lshl_b32 s29, s25, 3
    s_add_u32 s28, s28, s29
    s_add_u32 s28, s28, 34
    s_lshl_b32 s28, s28, 10
    s_add_u32 s28, s28, 13631488
    buffer_store_dwordx4 v[204:207], v6, s[12:15], s28 offen offset:0 sc0 sc1
    buffer_store_dwordx4 v[208:211], v6, s[12:15], s28 offen offset:1024 sc0 sc1
    s_lshl_b32 s28, s24, 1
    s_add_u32 s28, s28, 1
    s_mul_i32 s28, s28, 88
    s_lshl_b32 s29, s25, 3
    s_add_u32 s28, s28, s29
    s_add_u32 s28, s28, 34
    s_lshl_b32 s28, s28, 10
    s_add_u32 s28, s28, 13631488
    buffer_store_dwordx4 v[212:215], v6, s[12:15], s28 offen offset:0 sc0 sc1
    buffer_store_dwordx4 v[216:219], v6, s[12:15], s28 offen offset:1024 sc0 sc1
    s_branch L_p23_kernel_P3
L_p23_kernel_Bs1:
    s_cmp_eq_u32 s27, 2
    s_cbranch_scc0 L_p23_kernel_Bs2
    v_add_u32 v3, 8192, v2
    ds_write_b128 v3, v[12:15] offset:0
    ds_write_b128 v3, v[16:19] offset:1024
    ds_write_b128 v3, v[20:23] offset:2048
    ds_write_b128 v3, v[24:27] offset:3072
    ds_write_b128 v3, v[28:31] offset:4096
    ds_write_b128 v3, v[32:35] offset:5120
    ds_write_b128 v3, v[36:39] offset:6144
    ds_write_b128 v3, v[40:43] offset:7168
    v_add_u32 v3, 24576, v2
    ds_write_b128 v3, v[44:47] offset:0
    ds_write_b128 v3, v[48:51] offset:1024
    ds_write_b128 v3, v[52:55] offset:2048
    ds_write_b128 v3, v[56:59] offset:3072
    ds_write_b128 v3, v[60:63] offset:4096
    ds_write_b128 v3, v[64:67] offset:5120
    ds_write_b128 v3, v[68:71] offset:6144
    ds_write_b128 v3, v[72:75] offset:7168
    v_add_u32 v3, 106496, v2
    ds_write_b128 v3, v[108:111] offset:0
    ds_write_b128 v3, v[112:115] offset:1024
    ds_write_b128 v3, v[116:119] offset:2048
    ds_write_b128 v3, v[120:123] offset:3072
    ds_write_b128 v3, v[124:127] offset:4096
    ds_write_b128 v3, v[128:131] offset:5120
    ds_write_b128 v3, v[132:135] offset:6144
    ds_write_b128 v3, v[136:139] offset:7168
    s_waitcnt lgkmcnt(0)
    v_mov_b32 v4, 49160
    v_mov_b32 v5, 2143387585
    ds_write_b32 v4, v5
    v_and_b32 v4, 3, v1
    v_lshlrev_b32 v4, 2, v4
    v_add_u32 v4, 49152, v4
    s_mov_b32 s36, 1048576
    s_mov_b32 s28, 2143387585
L_p23_kernel_hs2:
    ds_read_b32 v3, v4
    s_waitcnt lgkmcnt(0)
    v_cmp_ne_u32 vcc, s28, v3
    s_sub_u32 s36, s36, 1
    s_cbranch_vccz L_p23_kernel_hs2ok
    s_cmp_eq_u32 s36, 0
    s_cbranch_scc0 L_p23_kernel_hs2
L_p23_kernel_hs2ok:
    v_add_u32 v3, 65536, v2
    ds_read_b128 v[140:143], v3 offset:0
    ds_read_b128 v[144:147], v3 offset:1024
    ds_read_b128 v[148:151], v3 offset:2048
    ds_read_b128 v[152:155], v3 offset:3072
    ds_read_b128 v[156:159], v3 offset:8192
    ds_read_b128 v[160:163], v3 offset:9216
    ds_read_b128 v[164:167], v3 offset:10240
    ds_read_b128 v[168:171], v3 offset:11264
    ds_read_b128 v[172:175], v3 offset:16384
    ds_read_b128 v[176:179], v3 offset:17408
    ds_read_b128 v[180:183], v3 offset:18432
    ds_read_b128 v[184:187], v3 offset:19456
    s_waitcnt lgkmcnt(0)
    ds_read_b128 v[12:15], v3 offset:4096
    ds_read_b128 v[16:19], v3 offset:5120
    ds_read_b128 v[20:23], v3 offset:6144
    ds_read_b128 v[24:27], v3 offset:7168
    ds_read_b128 v[28:31], v3 offset:12288
    ds_read_b128 v[32:35], v3 offset:13312
    ds_read_b128 v[36:39], v3 offset:14336
    ds_read_b128 v[40:43], v3 offset:15360
    ds_read_b128 v[44:47], v3 offset:20480
    ds_read_b128 v[48:51], v3 offset:21504
    ds_read_b128 v[52:55], v3 offset:22528
    ds_read_b128 v[56:59], v3 offset:23552
    s_waitcnt lgkmcnt(0) vmcnt(0)
    v_add_f32 v76, v76, v140
    v_add_f32 v77, v77, v141
    v_add_f32 v78, v78, v142
    v_add_f32 v79, v79, v143
    v_add_f32 v80, v80, v144
    v_add_f32 v81, v81, v145
    v_add_f32 v82, v82, v146
    v_add_f32 v83, v83, v147
    v_add_f32 v84, v84, v148
    v_add_f32 v85, v85, v149
    v_add_f32 v86, v86, v150
    v_add_f32 v87, v87, v151
    v_add_f32 v88, v88, v152
    v_add_f32 v89, v89, v153
    v_add_f32 v90, v90, v154
    v_add_f32 v91, v91, v155
    s_add_u32 m0, s45, 0
    s_add_u32 s30, s46, 0
    buffer_load_dwordx4 v7, s[60:63], s30 offen lds
    s_add_u32 m0, s45, 1024
    s_add_u32 s30, s46, 8192
    buffer_load_dwordx4 v7, s[60:63], s30 offen lds
    v_add_f32 v76, v76, v156
    v_add_f32 v77, v77, v157
    v_add_f32 v78, v78, v158
    v_add_f32 v79, v79, v159
    v_add_f32 v80, v80, v160
    v_add_f32 v81, v81, v161
    v_add_f32 v82, v82, v162
    v_add_f32 v83, v83, v163
    v_add_f32 v84, v84, v164
    v_add_f32 v85, v85, v165
    v_add_f32 v86, v86, v166
    v_add_f32 v87, v87, v167
    v_add_f32 v88, v88, v168
    v_add_f32 v89, v89, v169
    v_add_f32 v90, v90, v170
    v_add_f32 v91, v91, v171
    s_add_u32 m0, s45, 2048
    s_add_u32 s30, s46, 16384
    buffer_load_dwordx4 v7, s[60:63], s30 offen lds
    s_add_u32 m0, s45, 3072
    s_add_u32 s30, s46, 24576
    buffer_load_dwordx4 v7, s[60:63], s30 offen lds
    v_add_f32 v76, v76, v172
    v_add_f32 v77, v77, v173
    v_add_f32 v78, v78, v174
    v_add_f32 v79, v79, v175
    v_add_f32 v80, v80, v176
    v_add_f32 v81, v81, v177
    v_add_f32 v82, v82, v178
    v_add_f32 v83, v83, v179
    v_add_f32 v84, v84, v180
    v_add_f32 v85, v85, v181
    v_add_f32 v86, v86, v182
    v_add_f32 v87, v87, v183
    v_add_f32 v88, v88, v184
    v_add_f32 v89, v89, v185
    v_add_f32 v90, v90, v186
    v_add_f32 v91, v91, v187
    s_add_u32 m0, s45, 4096
    s_add_u32 s30, s46, 32768
    buffer_load_dwordx4 v7, s[60:63], s30 offen lds
    s_add_u32 m0, s45, 5120
    s_add_u32 s30, s46, 40960
    buffer_load_dwordx4 v7, s[60:63], s30 offen lds
    v_lshlrev_b32 v60, 16, v204
    v_and_b32 v61, 0xffff0000, v204
    v_mul_f32 v60, v60, v76
    v_mul_f32 v61, v61, v77
    v_cvt_pk_bf16_f32 v204, v60, v61
    v_lshlrev_b32 v60, 16, v205
    v_and_b32 v61, 0xffff0000, v205
    v_mul_f32 v60, v60, v78
    v_mul_f32 v61, v61, v79
    v_cvt_pk_bf16_f32 v205, v60, v61
    v_lshlrev_b32 v60, 16, v206
    v_and_b32 v61, 0xffff0000, v206
    v_mul_f32 v60, v60, v80
    v_mul_f32 v61, v61, v81
    v_cvt_pk_bf16_f32 v206, v60, v61
    s_add_u32 m0, s45, 6144
    s_add_u32 s30, s46, 49152
    buffer_load_dwordx4 v7, s[60:63], s30 offen lds
    s_add_u32 m0, s45, 7168
    s_add_u32 s30, s46, 57344
    buffer_load_dwordx4 v7, s[60:63], s30 offen lds
    v_lshlrev_b32 v60, 16, v207
    v_and_b32 v61, 0xffff0000, v207
    v_mul_f32 v60, v60, v82
    v_mul_f32 v61, v61, v83
    v_cvt_pk_bf16_f32 v207, v60, v61
    v_lshlrev_b32 v60, 16, v208
    v_and_b32 v61, 0xffff0000, v208
    v_mul_f32 v60, v60, v84
    v_mul_f32 v61, v61, v85
    v_cvt_pk_bf16_f32 v208, v60, v61
    s_add_u32 m0, s45, 8192
    s_add_u32 s30, s46, 65536
    buffer_load_dwordx4 v7, s[60:63], s30 offen lds
    s_add_u32 m0, s45, 9216
    s_add_u32 s30, s46, 73728
    buffer_load_dwordx4 v7, s[60:63], s30 offen lds
    v_lshlrev_b32 v60, 16, v209
    v_and_b32 v61, 0xffff0000, v209
    v_mul_f32 v60, v60, v86
    v_mul_f32 v61, v61, v87
    v_cvt_pk_bf16_f32 v209, v60, v61
    v_lshlrev_b32 v60, 16, v210
    v_and_b32 v61, 0xffff0000, v210
    v_mul_f32 v60, v60, v88
    v_mul_f32 v61, v61, v89
    v_cvt_pk_bf16_f32 v210, v60, v61
    s_add_u32 m0, s45, 10240
    s_add_u32 s30, s46, 81920
    buffer_load_dwordx4 v7, s[60:63], s30 offen lds
    s_add_u32 m0, s45, 11264
    s_add_u32 s30, s46, 90112
    buffer_load_dwordx4 v7, s[60:63], s30 offen lds
    v_lshlrev_b32 v60, 16, v211
    v_and_b32 v61, 0xffff0000, v211
    v_mul_f32 v60, v60, v90
    v_mul_f32 v61, v61, v91
    v_cvt_pk_bf16_f32 v211, v60, v61
    v_add_f32 v92, v92, v12
    v_add_f32 v93, v93, v13
    v_add_f32 v94, v94, v14
    v_add_f32 v95, v95, v15
    v_add_f32 v96, v96, v16
    v_add_f32 v97, v97, v17
    v_add_f32 v98, v98, v18
    v_add_f32 v99, v99, v19
    v_add_f32 v100, v100, v20
    v_add_f32 v101, v101, v21
    v_add_f32 v102, v102, v22
    v_add_f32 v103, v103, v23
    v_add_f32 v104, v104, v24
    v_add_f32 v105, v105, v25
    v_add_f32 v106, v106, v26
    v_add_f32 v107, v107, v27
    s_add_u32 m0, s45, 12288
    s_add_u32 s30, s46, 98304
    buffer_load_dwordx4 v7, s[60:63], s30 offen lds
    s_add_u32 m0, s45, 13312
    s_add_u32 s30, s46, 106496
    buffer_load_dwordx4 v7, s[60:63], s30 offen lds
    v_add_f32 v92, v92, v28
    v_add_f32 v93, v93, v29
    v_add_f32 v94, v94, v30
    v_add_f32 v95, v95, v31
    v_add_f32 v96, v96, v32
    v_add_f32 v97, v97, v33
    v_add_f32 v98, v98, v34
    v_add_f32 v99, v99, v35
    v_add_f32 v100, v100, v36
    v_add_f32 v101, v101, v37
    v_add_f32 v102, v102, v38
    v_add_f32 v103, v103, v39
    v_add_f32 v104, v104, v40
    v_add_f32 v105, v105, v41
    v_add_f32 v106, v106, v42
    v_add_f32 v107, v107, v43
    s_add_u32 m0, s45, 14336
    s_add_u32 s30, s46, 114688
    buffer_load_dwordx4 v7, s[60:63], s30 offen lds
    s_add_u32 m0, s45, 15360
    s_add_u32 s30, s46, 122880
    buffer_load_dwordx4 v7, s[60:63], s30 offen lds
    v_add_f32 v92, v92, v44
    v_add_f32 v93, v93, v45
    v_add_f32 v94, v94, v46
    v_add_f32 v95, v95, v47
    v_add_f32 v96, v96, v48
    v_add_f32 v97, v97, v49
    v_add_f32 v98, v98, v50
    v_add_f32 v99, v99, v51
    v_add_f32 v100, v100, v52
    v_add_f32 v101, v101, v53
    v_add_f32 v102, v102, v54
    v_add_f32 v103, v103, v55
    v_add_f32 v104, v104, v56
    v_add_f32 v105, v105, v57
    v_add_f32 v106, v106, v58
    v_add_f32 v107, v107, v59
    s_add_u32 m0, s45, 16384
    s_add_u32 s30, s46, 131072
    buffer_load_dwordx4 v7, s[60:63], s30 offen lds
    s_add_u32 m0, s45, 17408
    s_add_u32 s30, s46, 139264
    buffer_load_dwordx4 v7, s[60:63], s30 offen lds
    v_lshlrev_b32 v60, 16, v212
    v_and_b32 v61, 0xffff0000, v212
    v_mul_f32 v60, v60, v92
    v_mul_f32 v61, v61, v93
    v_cvt_pk_bf16_f32 v212, v60, v61
    v_lshlrev_b32 v60, 16, v213
    v_and_b32 v61, 0xffff0000, v213
    v_mul_f32 v60, v60, v94
    v_mul_f32 v61, v61, v95
    v_cvt_pk_bf16_f32 v213, v60, v61
    v_lshlrev_b32 v60, 16, v214
    v_and_b32 v61, 0xffff0000, v214
    v_mul_f32 v60, v60, v96
    v_mul_f32 v61, v61, v97
    v_cvt_pk_bf16_f32 v214, v60, v61
    s_add_u32 m0, s45, 18432
    s_add_u32 s30, s46, 147456
    buffer_load_dwordx4 v7, s[60:63], s30 offen lds
    s_add_u32 m0, s45, 19456
    s_add_u32 s30, s46, 155648
    buffer_load_dwordx4 v7, s[60:63], s30 offen lds
    v_lshlrev_b32 v60, 16, v215
    v_and_b32 v61, 0xffff0000, v215
    v_mul_f32 v60, v60, v98
    v_mul_f32 v61, v61, v99
    v_cvt_pk_bf16_f32 v215, v60, v61
    v_lshlrev_b32 v60, 16, v216
    v_and_b32 v61, 0xffff0000, v216
    v_mul_f32 v60, v60, v100
    v_mul_f32 v61, v61, v101
    v_cvt_pk_bf16_f32 v216, v60, v61
    s_add_u32 m0, s45, 20480
    s_add_u32 s30, s46, 163840
    buffer_load_dwordx4 v7, s[60:63], s30 offen lds
    s_add_u32 m0, s45, 21504
    s_add_u32 s30, s46, 172032
    buffer_load_dwordx4 v7, s[60:63], s30 offen lds
    v_lshlrev_b32 v60, 16, v217
    v_and_b32 v61, 0xffff0000, v217
    v_mul_f32 v60, v60, v102
    v_mul_f32 v61, v61, v103
    v_cvt_pk_bf16_f32 v217, v60, v61
    v_lshlrev_b32 v60, 16, v218
    v_and_b32 v61, 0xffff0000, v218
    v_mul_f32 v60, v60, v104
    v_mul_f32 v61, v61, v105
    v_cvt_pk_bf16_f32 v218, v60, v61
    s_add_u32 m0, s45, 22528
    s_add_u32 s30, s46, 180224
    buffer_load_dwordx4 v7, s[60:63], s30 offen lds
    s_add_u32 m0, s45, 23552
    s_add_u32 s30, s46, 188416
    buffer_load_dwordx4 v7, s[60:63], s30 offen lds
    v_lshlrev_b32 v60, 16, v219
    v_and_b32 v61, 0xffff0000, v219
    v_mul_f32 v60, v60, v106
    v_mul_f32 v61, v61, v107
    v_cvt_pk_bf16_f32 v219, v60, v61
    v_cmp_ne_u32 vcc, 1, v225
    s_cbranch_vccz L_p23_kernel_mkb2done
    s_lshl_b32 s28, s24, 10
    s_add_u32 s28, s28, 2237312
    v_and_b32 v4, 3, v1
    v_lshlrev_b32 v4, 2, v4
    s_mov_b32 s29, s28
    s_mov_b32 s36, 1048576
L_p23_kernel_mkb2:
    buffer_load_dword v3, v4, s[12:15], s29 offen sc0 sc1
    s_waitcnt vmcnt(0)
    v_cmp_ne_u32 vcc, 1, v3
    s_sub_u32 s36, s36, 1
    s_cbranch_vccz L_p23_kernel_mkb2ok
    s_cmp_eq_u32 s36, 0
    s_cbranch_scc1 L_p23_kernel_mkb2ok
    s_sleep 1
    s_branch L_p23_kernel_mkb2
L_p23_kernel_mkb2ok:
L_p23_kernel_mkb2done:
    s_lshl_b32 s28, s24, 1
    s_add_u32 s28, s28, 0
    s_mul_i32 s28, s28, 88
    s_lshl_b32 s29, s25, 3
    s_add_u32 s28, s28, s29
    s_add_u32 s28, s28, 36
    s_lshl_b32 s28, s28, 10
    s_add_u32 s28, s28, 13631488
    buffer_store_dwordx4 v[204:207], v6, s[12:15], s28 offen offset:0 sc0 sc1
    buffer_store_dwordx4 v[208:211], v6, s[12:15], s28 offen offset:1024 sc0 sc1
    s_lshl_b32 s28, s24, 1
    s_add_u32 s28, s28, 1
    s_mul_i32 s28, s28, 88
    s_lshl_b32 s29, s25, 3
    s_add_u32 s28, s28, s29
    s_add_u32 s28, s28, 36
    s_lshl_b32 s28, s28, 10
    s_add_u32 s28, s28, 13631488
    buffer_store_dwordx4 v[212:215], v6, s[12:15], s28 offen offset:0 sc0 sc1
    buffer_store_dwordx4 v[216:219], v6, s[12:15], s28 offen offset:1024 sc0 sc1
    s_branch L_p23_kernel_P3
L_p23_kernel_Bs2:
    s_cmp_eq_u32 s27, 3
    s_cbranch_scc0 L_p23_kernel_Bs3
    v_add_u32 v3, 16384, v2
    ds_write_b128 v3, v[12:15] offset:0
    ds_write_b128 v3, v[16:19] offset:1024
    ds_write_b128 v3, v[20:23] offset:2048
    ds_write_b128 v3, v[24:27] offset:3072
    ds_write_b128 v3, v[28:31] offset:4096
    ds_write_b128 v3, v[32:35] offset:5120
    ds_write_b128 v3, v[36:39] offset:6144
    ds_write_b128 v3, v[40:43] offset:7168
    v_add_u32 v3, 32768, v2
    ds_write_b128 v3, v[44:47] offset:0
    ds_write_b128 v3, v[48:51] offset:1024
    ds_write_b128 v3, v[52:55] offset:2048
    ds_write_b128 v3, v[56:59] offset:3072
    ds_write_b128 v3, v[60:63] offset:4096
    ds_write_b128 v3, v[64:67] offset:5120
    ds_write_b128 v3, v[68:71] offset:6144
    ds_write_b128 v3, v[72:75] offset:7168
    v_add_u32 v3, 65536, v2
    ds_write_b128 v3, v[76:79] offset:0
    ds_write_b128 v3, v[80:83] offset:1024
    ds_write_b128 v3, v[84:87] offset:2048
    ds_write_b128 v3, v[88:91] offset:3072
    ds_write_b128 v3, v[92:95] offset:4096
    ds_write_b128 v3, v[96:99] offset:5120
    ds_write_b128 v3, v[100:103] offset:6144
    ds_write_b128 v3, v[104:107] offset:7168
    s_waitcnt lgkmcnt(0)
    v_mov_b32 v4, 49164
    v_mov_b32 v5, 2143387585
    ds_write_b32 v4, v5
    v_and_b32 v4, 3, v1
    v_lshlrev_b32 v4, 2, v4
    v_add_u32 v4, 49152, v4
    s_mov_b32 s36, 1048576
    s_mov_b32 s28, 2143387585
L_p23_kernel_hs3:
    ds_read_b32 v3, v4
    s_waitcnt lgkmcnt(0)
    v_cmp_ne_u32 vcc, s28, v3
    s_sub_u32 s36, s36, 1
    s_cbranch_vccz L_p23_kernel_hs3ok
    s_cmp_eq_u32 s36, 0
    s_cbranch_scc0 L_p23_kernel_hs3
L_p23_kernel_hs3ok:
    v_add_u32 v3, 90112, v2
    ds_read_b128 v[140:143], v3 offset:0
    ds_read_b128 v[144:147], v3 offset:1024
    ds_read_b128 v[148:151], v3 offset:2048
    ds_read_b128 v[152:155], v3 offset:3072
    ds_read_b128 v[156:159], v3 offset:8192
    ds_read_b128 v[160:163], v3 offset:9216
    ds_read_b128 v[164:167], v3 offset:10240
    ds_read_b128 v[168:171], v3 offset:11264
    ds_read_b128 v[172:175], v3 offset:16384
    ds_read_b128 v[176:179], v3 offset:17408
    ds_read_b128 v[180:183], v3 offset:18432
    ds_read_b128 v[184:187], v3 offset:19456
    s_waitcnt lgkmcnt(0)
    ds_read_b128 v[12:15], v3 offset:4096
    ds_read_b128 v[16:19], v3 offset:5120
    ds_read_b128 v[20:23], v3 offset:6144
    ds_read_b128 v[24:27], v3 offset:7168
    ds_read_b128 v[28:31], v3 offset:12288
    ds_read_b128 v[32:35], v3 offset:13312
    ds_read_b128 v[36:39], v3 offset:14336
    ds_read_b128 v[40:43], v3 offset:15360
    ds_read_b128 v[44:47], v3 offset:20480
    ds_read_b128 v[48:51], v3 offset:21504
    ds_read_b128 v[52:55], v3 offset:22528
    ds_read_b128 v[56:59], v3 offset:23552
    s_waitcnt lgkmcnt(0) vmcnt(0)
    v_add_f32 v108, v108, v140
    v_add_f32 v109, v109, v141
    v_add_f32 v110, v110, v142
    v_add_f32 v111, v111, v143
    v_add_f32 v112, v112, v144
    v_add_f32 v113, v113, v145
    v_add_f32 v114, v114, v146
    v_add_f32 v115, v115, v147
    v_add_f32 v116, v116, v148
    v_add_f32 v117, v117, v149
    v_add_f32 v118, v118, v150
    v_add_f32 v119, v119, v151
    v_add_f32 v120, v120, v152
    v_add_f32 v121, v121, v153
    v_add_f32 v122, v122, v154
    v_add_f32 v123, v123, v155
    s_add_u32 m0, s45, 0
    s_add_u32 s30, s46, 0
    buffer_load_dwordx4 v7, s[60:63], s30 offen lds
    s_add_u32 m0, s45, 1024
    s_add_u32 s30, s46, 8192
    buffer_load_dwordx4 v7, s[60:63], s30 offen lds
    v_add_f32 v108, v108, v156
    v_add_f32 v109, v109, v157
    v_add_f32 v110, v110, v158
    v_add_f32 v111, v111, v159
    v_add_f32 v112, v112, v160
    v_add_f32 v113, v113, v161
    v_add_f32 v114, v114, v162
    v_add_f32 v115, v115, v163
    v_add_f32 v116, v116, v164
    v_add_f32 v117, v117, v165
    v_add_f32 v118, v118, v166
    v_add_f32 v119, v119, v167
    v_add_f32 v120, v120, v168
    v_add_f32 v121, v121, v169
    v_add_f32 v122, v122, v170
    v_add_f32 v123, v123, v171
    s_add_u32 m0, s45, 2048
    s_add_u32 s30, s46, 16384
    buffer_load_dwordx4 v7, s[60:63], s30 offen lds
    s_add_u32 m0, s45, 3072
    s_add_u32 s30, s46, 24576
    buffer_load_dwordx4 v7, s[60:63], s30 offen lds
    v_add_f32 v108, v108, v172
    v_add_f32 v109, v109, v173
    v_add_f32 v110, v110, v174
    v_add_f32 v111, v111, v175
    v_add_f32 v112, v112, v176
    v_add_f32 v113, v113, v177
    v_add_f32 v114, v114, v178
    v_add_f32 v115, v115, v179
    v_add_f32 v116, v116, v180
    v_add_f32 v117, v117, v181
    v_add_f32 v118, v118, v182
    v_add_f32 v119, v119, v183
    v_add_f32 v120, v120, v184
    v_add_f32 v121, v121, v185
    v_add_f32 v122, v122, v186
    v_add_f32 v123, v123, v187
    s_add_u32 m0, s45, 4096
    s_add_u32 s30, s46, 32768
    buffer_load_dwordx4 v7, s[60:63], s30 offen lds
    s_add_u32 m0, s45, 5120
    s_add_u32 s30, s46, 40960
    buffer_load_dwordx4 v7, s[60:63], s30 offen lds
    v_lshlrev_b32 v60, 16, v204
    v_and_b32 v61, 0xffff0000, v204
    v_mul_f32 v60, v60, v108
    v_mul_f32 v61, v61, v109
    v_cvt_pk_bf16_f32 v204, v60, v61
    v_lshlrev_b32 v60, 16, v205
    v_and_b32 v61, 0xffff0000, v205
    v_mul_f32 v60, v60, v110
    v_mul_f32 v61, v61, v111
    v_cvt_pk_bf16_f32 v205, v60, v61
    v_lshlrev_b32 v60, 16, v206
    v_and_b32 v61, 0xffff0000, v206
    v_mul_f32 v60, v60, v112
    v_mul_f32 v61, v61, v113
    v_cvt_pk_bf16_f32 v206, v60, v61
    s_add_u32 m0, s45, 6144
    s_add_u32 s30, s46, 49152
    buffer_load_dwordx4 v7, s[60:63], s30 offen lds
    s_add_u32 m0, s45, 7168
    s_add_u32 s30, s46, 57344
    buffer_load_dwordx4 v7, s[60:63], s30 offen lds
    v_lshlrev_b32 v60, 16, v207
    v_and_b32 v61, 0xffff0000, v207
    v_mul_f32 v60, v60, v114
    v_mul_f32 v61, v61, v115
    v_cvt_pk_bf16_f32 v207, v60, v61
    v_lshlrev_b32 v60, 16, v208
    v_and_b32 v61, 0xffff0000, v208
    v_mul_f32 v60, v60, v116
    v_mul_f32 v61, v61, v117
    v_cvt_pk_bf16_f32 v208, v60, v61
    s_add_u32 m0, s45, 8192
    s_add_u32 s30, s46, 65536
    buffer_load_dwordx4 v7, s[60:63], s30 offen lds
    s_add_u32 m0, s45, 9216
    s_add_u32 s30, s46, 73728
    buffer_load_dwordx4 v7, s[60:63], s30 offen lds
    v_lshlrev_b32 v60, 16, v209
    v_and_b32 v61, 0xffff0000, v209
    v_mul_f32 v60, v60, v118
    v_mul_f32 v61, v61, v119
    v_cvt_pk_bf16_f32 v209, v60, v61
    v_lshlrev_b32 v60, 16, v210
    v_and_b32 v61, 0xffff0000, v210
    v_mul_f32 v60, v60, v120
    v_mul_f32 v61, v61, v121
    v_cvt_pk_bf16_f32 v210, v60, v61
    s_add_u32 m0, s45, 10240
    s_add_u32 s30, s46, 81920
    buffer_load_dwordx4 v7, s[60:63], s30 offen lds
    s_add_u32 m0, s45, 11264
    s_add_u32 s30, s46, 90112
    buffer_load_dwordx4 v7, s[60:63], s30 offen lds
    v_lshlrev_b32 v60, 16, v211
    v_and_b32 v61, 0xffff0000, v211
    v_mul_f32 v60, v60, v122
    v_mul_f32 v61, v61, v123
    v_cvt_pk_bf16_f32 v211, v60, v61
    v_add_f32 v124, v124, v12
    v_add_f32 v125, v125, v13
    v_add_f32 v126, v126, v14
    v_add_f32 v127, v127, v15
    v_add_f32 v128, v128, v16
    v_add_f32 v129, v129, v17
    v_add_f32 v130, v130, v18
    v_add_f32 v131, v131, v19
    v_add_f32 v132, v132, v20
    v_add_f32 v133, v133, v21
    v_add_f32 v134, v134, v22
    v_add_f32 v135, v135, v23
    v_add_f32 v136, v136, v24
    v_add_f32 v137, v137, v25
    v_add_f32 v138, v138, v26
    v_add_f32 v139, v139, v27
    s_add_u32 m0, s45, 12288
    s_add_u32 s30, s46, 98304
    buffer_load_dwordx4 v7, s[60:63], s30 offen lds
    s_add_u32 m0, s45, 13312
    s_add_u32 s30, s46, 106496
    buffer_load_dwordx4 v7, s[60:63], s30 offen lds
    v_add_f32 v124, v124, v28
    v_add_f32 v125, v125, v29
    v_add_f32 v126, v126, v30
    v_add_f32 v127, v127, v31
    v_add_f32 v128, v128, v32
    v_add_f32 v129, v129, v33
    v_add_f32 v130, v130, v34
    v_add_f32 v131, v131, v35
    v_add_f32 v132, v132, v36
    v_add_f32 v133, v133, v37
    v_add_f32 v134, v134, v38
    v_add_f32 v135, v135, v39
    v_add_f32 v136, v136, v40
    v_add_f32 v137, v137, v41
    v_add_f32 v138, v138, v42
    v_add_f32 v139, v139, v43
    s_add_u32 m0, s45, 14336
    s_add_u32 s30, s46, 114688
    buffer_load_dwordx4 v7, s[60:63], s30 offen lds
    s_add_u32 m0, s45, 15360
    s_add_u32 s30, s46, 122880
    buffer_load_dwordx4 v7, s[60:63], s30 offen lds
    v_add_f32 v124, v124, v44
    v_add_f32 v125, v125, v45
    v_add_f32 v126, v126, v46
    v_add_f32 v127, v127, v47
    v_add_f32 v128, v128, v48
    v_add_f32 v129, v129, v49
    v_add_f32 v130, v130, v50
    v_add_f32 v131, v131, v51
    v_add_f32 v132, v132, v52
    v_add_f32 v133, v133, v53
    v_add_f32 v134, v134, v54
    v_add_f32 v135, v135, v55
    v_add_f32 v136, v136, v56
    v_add_f32 v137, v137, v57
    v_add_f32 v138, v138, v58
    v_add_f32 v139, v139, v59
    s_add_u32 m0, s45, 16384
    s_add_u32 s30, s46, 131072
    buffer_load_dwordx4 v7, s[60:63], s30 offen lds
    s_add_u32 m0, s45, 17408
    s_add_u32 s30, s46, 139264
    buffer_load_dwordx4 v7, s[60:63], s30 offen lds
    v_lshlrev_b32 v60, 16, v212
    v_and_b32 v61, 0xffff0000, v212
    v_mul_f32 v60, v60, v124
    v_mul_f32 v61, v61, v125
    v_cvt_pk_bf16_f32 v212, v60, v61
    v_lshlrev_b32 v60, 16, v213
    v_and_b32 v61, 0xffff0000, v213
    v_mul_f32 v60, v60, v126
    v_mul_f32 v61, v61, v127
    v_cvt_pk_bf16_f32 v213, v60, v61
    v_lshlrev_b32 v60, 16, v214
    v_and_b32 v61, 0xffff0000, v214
    v_mul_f32 v60, v60, v128
    v_mul_f32 v61, v61, v129
    v_cvt_pk_bf16_f32 v214, v60, v61
    s_add_u32 m0, s45, 18432
    s_add_u32 s30, s46, 147456
    buffer_load_dwordx4 v7, s[60:63], s30 offen lds
    s_add_u32 m0, s45, 19456
    s_add_u32 s30, s46, 155648
    buffer_load_dwordx4 v7, s[60:63], s30 offen lds
    v_lshlrev_b32 v60, 16, v215
    v_and_b32 v61, 0xffff0000, v215
    v_mul_f32 v60, v60, v130
    v_mul_f32 v61, v61, v131
    v_cvt_pk_bf16_f32 v215, v60, v61
    v_lshlrev_b32 v60, 16, v216
    v_and_b32 v61, 0xffff0000, v216
    v_mul_f32 v60, v60, v132
    v_mul_f32 v61, v61, v133
    v_cvt_pk_bf16_f32 v216, v60, v61
    s_add_u32 m0, s45, 20480
    s_add_u32 s30, s46, 163840
    buffer_load_dwordx4 v7, s[60:63], s30 offen lds
    s_add_u32 m0, s45, 21504
    s_add_u32 s30, s46, 172032
    buffer_load_dwordx4 v7, s[60:63], s30 offen lds
    v_lshlrev_b32 v60, 16, v217
    v_and_b32 v61, 0xffff0000, v217
    v_mul_f32 v60, v60, v134
    v_mul_f32 v61, v61, v135
    v_cvt_pk_bf16_f32 v217, v60, v61
    v_lshlrev_b32 v60, 16, v218
    v_and_b32 v61, 0xffff0000, v218
    v_mul_f32 v60, v60, v136
    v_mul_f32 v61, v61, v137
    v_cvt_pk_bf16_f32 v218, v60, v61
    s_add_u32 m0, s45, 22528
    s_add_u32 s30, s46, 180224
    buffer_load_dwordx4 v7, s[60:63], s30 offen lds
    s_add_u32 m0, s45, 23552
    s_add_u32 s30, s46, 188416
    buffer_load_dwordx4 v7, s[60:63], s30 offen lds
    v_lshlrev_b32 v60, 16, v219
    v_and_b32 v61, 0xffff0000, v219
    v_mul_f32 v60, v60, v138
    v_mul_f32 v61, v61, v139
    v_cvt_pk_bf16_f32 v219, v60, v61
    v_cmp_ne_u32 vcc, 1, v225
    s_cbranch_vccz L_p23_kernel_mkb3done
    s_lshl_b32 s28, s24, 10
    s_add_u32 s28, s28, 2237312
    v_and_b32 v4, 3, v1
    v_lshlrev_b32 v4, 2, v4
    s_mov_b32 s29, s28
    s_mov_b32 s36, 1048576
L_p23_kernel_mkb3:
    buffer_load_dword v3, v4, s[12:15], s29 offen sc0 sc1
    s_waitcnt vmcnt(0)
    v_cmp_ne_u32 vcc, 1, v3
    s_sub_u32 s36, s36, 1
    s_cbranch_vccz L_p23_kernel_mkb3ok
    s_cmp_eq_u32 s36, 0
    s_cbranch_scc1 L_p23_kernel_mkb3ok
    s_sleep 1
    s_branch L_p23_kernel_mkb3
L_p23_kernel_mkb3ok:
L_p23_kernel_mkb3done:
    s_lshl_b32 s28, s24, 1
    s_add_u32 s28, s28, 0
    s_mul_i32 s28, s28, 88
    s_lshl_b32 s29, s25, 3
    s_add_u32 s28, s28, s29
    s_add_u32 s28, s28, 38
    s_lshl_b32 s28, s28, 10
    s_add_u32 s28, s28, 13631488
    buffer_store_dwordx4 v[204:207], v6, s[12:15], s28 offen offset:0 sc0 sc1
    buffer_store_dwordx4 v[208:211], v6, s[12:15], s28 offen offset:1024 sc0 sc1
    s_lshl_b32 s28, s24, 1
    s_add_u32 s28, s28, 1
    s_mul_i32 s28, s28, 88
    s_lshl_b32 s29, s25, 3
    s_add_u32 s28, s28, s29
    s_add_u32 s28, s28, 38
    s_lshl_b32 s28, s28, 10
    s_add_u32 s28, s28, 13631488
    buffer_store_dwordx4 v[212:215], v6, s[12:15], s28 offen offset:0 sc0 sc1
    buffer_store_dwordx4 v[216:219], v6, s[12:15], s28 offen offset:1024 sc0 sc1
    s_branch L_p23_kernel_P3
L_p23_kernel_Bs3:
    s_branch L_p23_kernel_P3
L_p23_kernel_Bidle:
    s_barrier
    v_lshlrev_b32 v2, 4, v1
    s_lshr_b32 s28, s27, 1
    s_lshl_b32 s28, s28, 16
    s_and_b32 s29, s27, 1
    s_mul_i32 s29, s29, 24576
    s_add_u32 s28, s28, s29
    s_add_u32 s28, s28, 16384
    s_add_u32 s29, s28, 2097152
    s_add_u32 m0, s28, 0
    s_add_u32 s30, s29, 0
    buffer_load_dwordx4 v2, s[12:15], s30 offen lds
    s_add_u32 m0, s28, 1024
    s_add_u32 s30, s29, 1024
    buffer_load_dwordx4 v2, s[12:15], s30 offen lds
    s_add_u32 m0, s28, 2048
    s_add_u32 s30, s29, 2048
    buffer_load_dwordx4 v2, s[12:15], s30 offen lds
    s_add_u32 m0, s28, 3072
    s_add_u32 s30, s29, 3072
    buffer_load_dwordx4 v2, s[12:15], s30 offen lds
    s_add_u32 m0, s28, 4096
    s_add_u32 s30, s29, 4096
    buffer_load_dwordx4 v2, s[12:15], s30 offen lds
    s_add_u32 m0, s28, 5120
    s_add_u32 s30, s29, 5120
    buffer_load_dwordx4 v2, s[12:15], s30 offen lds
    s_add_u32 m0, s28, 6144
    s_add_u32 s30, s29, 6144
    buffer_load_dwordx4 v2, s[12:15], s30 offen lds
    s_add_u32 m0, s28, 7168
    s_add_u32 s30, s29, 7168
    buffer_load_dwordx4 v2, s[12:15], s30 offen lds
    s_add_u32 m0, s28, 8192
    s_add_u32 s30, s29, 8192
    buffer_load_dwordx4 v2, s[12:15], s30 offen lds
    s_add_u32 m0, s28, 9216
    s_add_u32 s30, s29, 9216
    buffer_load_dwordx4 v2, s[12:15], s30 offen lds
    s_add_u32 m0, s28, 10240
    s_add_u32 s30, s29, 10240
    buffer_load_dwordx4 v2, s[12:15], s30 offen lds
    s_add_u32 m0, s28, 11264
    s_add_u32 s30, s29, 11264
    buffer_load_dwordx4 v2, s[12:15], s30 offen lds
    s_add_u32 m0, s28, 12288
    s_add_u32 s30, s29, 12288
    buffer_load_dwordx4 v2, s[12:15], s30 offen lds
    s_add_u32 m0, s28, 13312
    s_add_u32 s30, s29, 13312
    buffer_load_dwordx4 v2, s[12:15], s30 offen lds
    s_add_u32 m0, s28, 14336
    s_add_u32 s30, s29, 14336
    buffer_load_dwordx4 v2, s[12:15], s30 offen lds
    s_add_u32 m0, s28, 15360
    s_add_u32 s30, s29, 15360
    buffer_load_dwordx4 v2, s[12:15], s30 offen lds
    s_add_u32 m0, s28, 16384
    s_add_u32 s30, s29, 16384
    buffer_load_dwordx4 v2, s[12:15], s30 offen lds
    s_add_u32 m0, s28, 17408
    s_add_u32 s30, s29, 17408
    buffer_load_dwordx4 v2, s[12:15], s30 offen lds
    s_add_u32 m0, s28, 18432
    s_add_u32 s30, s29, 18432
    buffer_load_dwordx4 v2, s[12:15], s30 offen lds
    s_add_u32 m0, s28, 19456
    s_add_u32 s30, s29, 19456
    buffer_load_dwordx4 v2, s[12:15], s30 offen lds
    s_add_u32 m0, s28, 20480
    s_add_u32 s30, s29, 20480
    buffer_load_dwordx4 v2, s[12:15], s30 offen lds
    s_add_u32 m0, s28, 21504
    s_add_u32 s30, s29, 21504
    buffer_load_dwordx4 v2, s[12:15], s30 offen lds
    s_add_u32 m0, s28, 22528
    s_add_u32 s30, s29, 22528
    buffer_load_dwordx4 v2, s[12:15], s30 offen lds
    s_add_u32 m0, s28, 23552
    s_add_u32 s30, s29, 23552
    buffer_load_dwordx4 v2, s[12:15], s30 offen lds
    s_mul_i32 s46, s27, 229376
    s_lshl_b32 s47, s27, 17
    s_and_b32 s28, s27, 1
    s_mul_i32 s45, s28, 24576
    s_lshr_b32 s28, s27, 1
    s_lshl_b32 s28, s28, 16
    s_add_u32 s45, s45, s28
    v_lshrrev_b32 v7, 3, v1
    v_lshlrev_b32 v7, 10, v7
    v_bfe_u32 v3, v1, 4, 1
    v_lshlrev_b32 v3, 2, v3
    v_xor_b32 v3, v3, v1
    v_and_b32 v3, 7, v3
    v_lshlrev_b32 v3, 4, v3
    v_add_u32 v7, v7, v3
    s_lshl_b32 s28, s25, 7
    v_add_u32 v7, s28, v7
    s_add_u32 m0, s39, 0
    s_add_u32 s30, s46, 196608
    buffer_load_dwordx4 v7, s[60:63], s30 offen lds
    s_add_u32 m0, s39, 1024
    s_add_u32 s30, s46, 204800
    buffer_load_dwordx4 v7, s[60:63], s30 offen lds
    s_add_u32 m0, s39, 2048
    s_add_u32 s30, s46, 212992
    buffer_load_dwordx4 v7, s[60:63], s30 offen lds
    s_add_u32 m0, s39, 3072
    s_add_u32 s30, s46, 221184
    buffer_load_dwordx4 v7, s[60:63], s30 offen lds
    s_add_u32 m0, s39, 4096
    s_add_u32 s30, s47, 0
    buffer_load_dwordx4 v7, s[56:59], s30 offen lds
    s_add_u32 m0, s39, 5120
    s_add_u32 s30, s47, 8192
    buffer_load_dwordx4 v7, s[56:59], s30 offen lds
    s_add_u32 m0, s39, 6144
    s_add_u32 s30, s47, 16384
    buffer_load_dwordx4 v7, s[56:59], s30 offen lds
    s_add_u32 m0, s39, 7168
    s_add_u32 s30, s47, 24576
    buffer_load_dwordx4 v7, s[56:59], s30 offen lds
    s_waitcnt vmcnt(0)
    s_barrier
    v_mov_b32 v140, -1
    v_mov_b32 v141, -1
    v_mov_b32 v142, -1
    v_mov_b32 v143, -1
    s_lshl_b32 s28, s24, 1
    s_mul_i32 s28, s28, 88
    s_mul_i32 s29, s27, 44
    s_add_u32 s28, s28, s29
    s_lshl_b32 s28, s28, 10
    s_add_u32 s28, s28, 13631488
    buffer_store_dwordx4 v[140:143], v6, s[12:15], s28 offen offset:0 sc0 sc1
    buffer_store_dwordx4 v[140:143], v6, s[12:15], s28 offen offset:1024 sc0 sc1
    buffer_store_dwordx4 v[140:143], v6, s[12:15], s28 offen offset:2048 sc0 sc1
    buffer_store_dwordx4 v[140:143], v6, s[12:15], s28 offen offset:3072 sc0 sc1
    s_add_u32 s28, s28, 4096
    buffer_store_dwordx4 v[140:143], v6, s[12:15], s28 offen offset:0 sc0 sc1
    buffer_store_dwordx4 v[140:143], v6, s[12:15], s28 offen offset:1024 sc0 sc1
    buffer_store_dwordx4 v[140:143], v6, s[12:15], s28 offen offset:2048 sc0 sc1
    buffer_store_dwordx4 v[140:143], v6, s[12:15], s28 offen offset:3072 sc0 sc1
    s_add_u32 s28, s28, 4096
    buffer_store_dwordx4 v[140:143], v6, s[12:15], s28 offen offset:0 sc0 sc1
    buffer_store_dwordx4 v[140:143], v6, s[12:15], s28 offen offset:1024 sc0 sc1
    buffer_store_dwordx4 v[140:143], v6, s[12:15], s28 offen offset:2048 sc0 sc1
    buffer_store_dwordx4 v[140:143], v6, s[12:15], s28 offen offset:3072 sc0 sc1
    s_add_u32 s28, s28, 4096
    buffer_store_dwordx4 v[140:143], v6, s[12:15], s28 offen offset:0 sc0 sc1
    buffer_store_dwordx4 v[140:143], v6, s[12:15], s28 offen offset:1024 sc0 sc1
    buffer_store_dwordx4 v[140:143], v6, s[12:15], s28 offen offset:2048 sc0 sc1
    buffer_store_dwordx4 v[140:143], v6, s[12:15], s28 offen offset:3072 sc0 sc1
    s_add_u32 s28, s28, 4096
    buffer_store_dwordx4 v[140:143], v6, s[12:15], s28 offen offset:0 sc0 sc1
    buffer_store_dwordx4 v[140:143], v6, s[12:15], s28 offen offset:1024 sc0 sc1
    buffer_store_dwordx4 v[140:143], v6, s[12:15], s28 offen offset:2048 sc0 sc1
    buffer_store_dwordx4 v[140:143], v6, s[12:15], s28 offen offset:3072 sc0 sc1
    s_add_u32 s28, s28, 4096
    buffer_store_dwordx4 v[140:143], v6, s[12:15], s28 offen offset:0 sc0 sc1
    buffer_store_dwordx4 v[140:143], v6, s[12:15], s28 offen offset:1024 sc0 sc1
    buffer_store_dwordx4 v[140:143], v6, s[12:15], s28 offen offset:2048 sc0 sc1
    buffer_store_dwordx4 v[140:143], v6, s[12:15], s28 offen offset:3072 sc0 sc1
    s_add_u32 s28, s28, 4096
    buffer_store_dwordx4 v[140:143], v6, s[12:15], s28 offen offset:0 sc0 sc1
    buffer_store_dwordx4 v[140:143], v6, s[12:15], s28 offen offset:1024 sc0 sc1
    buffer_store_dwordx4 v[140:143], v6, s[12:15], s28 offen offset:2048 sc0 sc1
    buffer_store_dwordx4 v[140:143], v6, s[12:15], s28 offen offset:3072 sc0 sc1
    s_add_u32 s28, s28, 4096
    buffer_store_dwordx4 v[140:143], v6, s[12:15], s28 offen offset:0 sc0 sc1
    buffer_store_dwordx4 v[140:143], v6, s[12:15], s28 offen offset:1024 sc0 sc1
    buffer_store_dwordx4 v[140:143], v6, s[12:15], s28 offen offset:2048 sc0 sc1
    buffer_store_dwordx4 v[140:143], v6, s[12:15], s28 offen offset:3072 sc0 sc1
    s_add_u32 s28, s28, 4096
    buffer_store_dwordx4 v[140:143], v6, s[12:15], s28 offen offset:0 sc0 sc1
    buffer_store_dwordx4 v[140:143], v6, s[12:15], s28 offen offset:1024 sc0 sc1
    buffer_store_dwordx4 v[140:143], v6, s[12:15], s28 offen offset:2048 sc0 sc1
    buffer_store_dwordx4 v[140:143], v6, s[12:15], s28 offen offset:3072 sc0 sc1
    s_add_u32 s28, s28, 4096
    buffer_store_dwordx4 v[140:143], v6, s[12:15], s28 offen offset:0 sc0 sc1
    buffer_store_dwordx4 v[140:143], v6, s[12:15], s28 offen offset:1024 sc0 sc1
    buffer_store_dwordx4 v[140:143], v6, s[12:15], s28 offen offset:2048 sc0 sc1
    buffer_store_dwordx4 v[140:143], v6, s[12:15], s28 offen offset:3072 sc0 sc1
    s_add_u32 s28, s28, 4096
    buffer_store_dwordx4 v[140:143], v6, s[12:15], s28 offen offset:0 sc0 sc1
    buffer_store_dwordx4 v[140:143], v6, s[12:15], s28 offen offset:1024 sc0 sc1
    buffer_store_dwordx4 v[140:143], v6, s[12:15], s28 offen offset:2048 sc0 sc1
    buffer_store_dwordx4 v[140:143], v6, s[12:15], s28 offen offset:3072 sc0 sc1
    s_add_u32 s28, s28, 4096
    s_waitcnt vmcnt(0)
    s_lshl_b32 s28, s24, 10
    s_lshl_b32 s29, s25, 7
    s_add_u32 s28, s28, s29
    s_lshl_b32 s29, s27, 2
    s_add_u32 s28, s28, s29
    s_add_u32 s28, s28, 2236416
    v_mov_b32 v2, 0
    v_mov_b32 v3, 1
    buffer_store_dword v3, v2, s[12:15], s28 offen sc0 sc1
    s_lshl_b32 s28, s24, 10
    s_add_u32 s28, s28, 2237312
    v_and_b32 v4, 3, v1
    v_lshlrev_b32 v4, 2, v4
    s_mov_b32 s29, s28
    s_mov_b32 s36, 1048576
L_p23_kernel_mki:
    buffer_load_dword v3, v4, s[12:15], s29 offen sc0 sc1
    s_waitcnt vmcnt(0)
    v_cmp_ne_u32 vcc, 1, v3
    s_sub_u32 s36, s36, 1
    s_cbranch_vccz L_p23_kernel_mkiok
    s_cmp_eq_u32 s36, 0
    s_cbranch_scc1 L_p23_kernel_mkiok
    s_sleep 1
    s_branch L_p23_kernel_mki
L_p23_kernel_mkiok:
    s_barrier
    s_add_u32 m0, s45, 0
    s_add_u32 s30, s46, 0
    buffer_load_dwordx4 v7, s[60:63], s30 offen lds
    s_add_u32 m0, s45, 1024
    s_add_u32 s30, s46, 8192
    buffer_load_dwordx4 v7, s[60:63], s30 offen lds
    s_add_u32 m0, s45, 2048
    s_add_u32 s30, s46, 16384
    buffer_load_dwordx4 v7, s[60:63], s30 offen lds
    s_add_u32 m0, s45, 3072
    s_add_u32 s30, s46, 24576
    buffer_load_dwordx4 v7, s[60:63], s30 offen lds
    s_add_u32 m0, s45, 4096
    s_add_u32 s30, s46, 32768
    buffer_load_dwordx4 v7, s[60:63], s30 offen lds
    s_add_u32 m0, s45, 5120
    s_add_u32 s30, s46, 40960
    buffer_load_dwordx4 v7, s[60:63], s30 offen lds
    s_add_u32 m0, s45, 6144
    s_add_u32 s30, s46, 49152
    buffer_load_dwordx4 v7, s[60:63], s30 offen lds
    s_add_u32 m0, s45, 7168
    s_add_u32 s30, s46, 57344
    buffer_load_dwordx4 v7, s[60:63], s30 offen lds
    s_add_u32 m0, s45, 8192
    s_add_u32 s30, s46, 65536
    buffer_load_dwordx4 v7, s[60:63], s30 offen lds
    s_add_u32 m0, s45, 9216
    s_add_u32 s30, s46, 73728
    buffer_load_dwordx4 v7, s[60:63], s30 offen lds
    s_add_u32 m0, s45, 10240
    s_add_u32 s30, s46, 81920
    buffer_load_dwordx4 v7, s[60:63], s30 offen lds
    s_add_u32 m0, s45, 11264
    s_add_u32 s30, s46, 90112
    buffer_load_dwordx4 v7, s[60:63], s30 offen lds
    s_add_u32 m0, s45, 12288
    s_add_u32 s30, s46, 98304
    buffer_load_dwordx4 v7, s[60:63], s30 offen lds
    s_add_u32 m0, s45, 13312
    s_add_u32 s30, s46, 106496
    buffer_load_dwordx4 v7, s[60:63], s30 offen lds
    s_add_u32 m0, s45, 14336
    s_add_u32 s30, s46, 114688
    buffer_load_dwordx4 v7, s[60:63], s30 offen lds
    s_add_u32 m0, s45, 15360
    s_add_u32 s30, s46, 122880
    buffer_load_dwordx4 v7, s[60:63], s30 offen lds
    s_add_u32 m0, s45, 16384
    s_add_u32 s30, s46, 131072
    buffer_load_dwordx4 v7, s[60:63], s30 offen lds
    s_add_u32 m0, s45, 17408
    s_add_u32 s30, s46, 139264
    buffer_load_dwordx4 v7, s[60:63], s30 offen lds
    s_add_u32 m0, s45, 18432
    s_add_u32 s30, s46, 147456
    buffer_load_dwordx4 v7, s[60:63], s30 offen lds
    s_add_u32 m0, s45, 19456
    s_add_u32 s30, s46, 155648
    buffer_load_dwordx4 v7, s[60:63], s30 offen lds
    s_add_u32 m0, s45, 20480
    s_add_u32 s30, s46, 163840
    buffer_load_dwordx4 v7, s[60:63], s30 offen lds
    s_add_u32 m0, s45, 21504
    s_add_u32 s30, s46, 172032
    buffer_load_dwordx4 v7, s[60:63], s30 offen lds
    s_add_u32 m0, s45, 22528
    s_add_u32 s30, s46, 180224
    buffer_load_dwordx4 v7, s[60:63], s30 offen lds
    s_add_u32 m0, s45, 23552
    s_add_u32 s30, s46, 188416
    buffer_load_dwordx4 v7, s[60:63], s30 offen lds
L_p23_kernel_P3:
    v_lshrrev_b32 v2, 3, v0
    s_lshl_b32 s28, s24, 6
    v_add_u32 v2, s28, v2
    v_lshlrev_b32 v2, 10, v2
    v_and_b32 v3, 7, v0
    v_lshlrev_b32 v3, 4, v3
    v_add_u32 v2, v2, v3
    s_lshl_b32 s28, s25, 7
    v_add_u32 v224, s28, v2
    buffer_load_dwordx4 v[220:223], v224, s[48:51], 0 offen
    v_lshrrev_b32 v10, 5, v1
    v_lshlrev_b32 v10, 2, v10
    v_bfe_u32 v2, v1, 2, 2
    v_add_u32 v10, v10, v2
    v_lshlrev_b32 v10, 7, v10
    v_bfe_u32 v2, v1, 3, 1
    v_lshlrev_b32 v2, 6, v2
    v_add_u32 v10, v10, v2
    v_bfe_u32 v2, v1, 4, 1
    v_lshlrev_b32 v2, 5, v2
    v_add_u32 v10, v10, v2
    v_and_b32 v2, 3, v1
    v_lshlrev_b32 v2, 3, v2
    v_add_u32 v10, v10, v2
    v_add_u32 v8, s45, v10
    v_xor_b32 v9, 64, v8
    v_add_u32 v11, s39, v10
    v_xor_b32 v236, 64, v11
    s_lshl_b32 s28, s24, 1
    s_mul_i32 s28, s28, 88
    s_lshl_b32 s28, s28, 10
    s_add_u32 s32, s28, 13631488
    v_and_b32 v4, 7, v1
    v_min_u32 v4, 6, v4
    s_mul_i32 s28, s27, 7
    v_add_u32 v4, s28, v4
    v_lshlrev_b32 v4, 1, v4
    v_add_u32 v4, 121, v4
    v_lshlrev_b32 v5, 10, v4
    s_mov_b32 s36, 1048576
L_p23_kernel_pa:
    buffer_load_dword v3, v5, s[12:15], s32 offen sc0 sc1
    s_waitcnt vmcnt(0)
    v_cmp_eq_u32 vcc, -1, v3
    s_sub_u32 s36, s36, 1
    s_cbranch_vccz L_p23_kernel_paok
    s_cmp_eq_u32 s36, 0
    s_cbranch_scc1 L_p23_kernel_paok
    s_sleep 1
    s_branch L_p23_kernel_pa
L_p23_kernel_paok:
    s_mul_i32 s33, s27, 14336
    s_add_u32 s33, s33, 32768
    s_add_u32 s33, s33, s32
    s_add_u32 s28, s33, 0
    buffer_load_dwordx4 v[76:79], v6, s[12:15], s28 offen sc0 sc1
    s_add_u32 s28, s33, 90112
    buffer_load_dwordx4 v[80:83], v6, s[12:15], s28 offen sc0 sc1
    s_add_u32 s28, s33, 1024
    buffer_load_dwordx4 v[84:87], v6, s[12:15], s28 offen sc0 sc1
    s_add_u32 s28, s33, 91136
    buffer_load_dwordx4 v[88:91], v6, s[12:15], s28 offen sc0 sc1
    s_add_u32 s28, s33, 2048
    buffer_load_dwordx4 v[92:95], v6, s[12:15], s28 offen sc0 sc1
    s_add_u32 s28, s33, 92160
    buffer_load_dwordx4 v[96:99], v6, s[12:15], s28 offen sc0 sc1
    s_add_u32 s28, s33, 3072
    buffer_load_dwordx4 v[100:103], v6, s[12:15], s28 offen sc0 sc1
    s_add_u32 s28, s33, 93184
    buffer_load_dwordx4 v[104:107], v6, s[12:15], s28 offen sc0 sc1
    s_add_u32 s28, s33, 4096
    buffer_load_dwordx4 v[108:111], v6, s[12:15], s28 offen sc0 sc1
    s_add_u32 s28, s33, 94208
    buffer_load_dwordx4 v[112:115], v6, s[12:15], s28 offen sc0 sc1
    s_add_u32 s28, s33, 5120
    buffer_load_dwordx4 v[116:119], v6, s[12:15], s28 offen sc0 sc1
    s_add_u32 s28, s33, 95232
    buffer_load_dwordx4 v[120:123], v6, s[12:15], s28 offen sc0 sc1
    s_add_u32 s28, s33, 6144
    buffer_load_dwordx4 v[124:127], v6, s[12:15], s28 offen sc0 sc1
    s_add_u32 s28, s33, 96256
    buffer_load_dwordx4 v[128:131], v6, s[12:15], s28 offen sc0 sc1
    s_add_u32 s28, s33, 7168
    buffer_load_dwordx4 v[132:135], v6, s[12:15], s28 offen sc0 sc1
    s_add_u32 s28, s33, 97280
    buffer_load_dwordx4 v[136:139], v6, s[12:15], s28 offen sc0 sc1
    s_add_u32 s28, s33, 8192
    buffer_load_dwordx4 v[140:143], v6, s[12:15], s28 offen sc0 sc1
    s_add_u32 s28, s33, 98304
    buffer_load_dwordx4 v[144:147], v6, s[12:15], s28 offen sc0 sc1
    s_add_u32 s28, s33, 9216
    buffer_load_dwordx4 v[148:151], v6, s[12:15], s28 offen sc0 sc1
    s_add_u32 s28, s33, 99328
    buffer_load_dwordx4 v[152:155], v6, s[12:15], s28 offen sc0 sc1
    s_add_u32 s28, s33, 10240
    buffer_load_dwordx4 v[156:159], v6, s[12:15], s28 offen sc0 sc1
    s_add_u32 s28, s33, 100352
    buffer_load_dwordx4 v[160:163], v6, s[12:15], s28 offen sc0 sc1
    s_add_u32 s28, s33, 11264
    buffer_load_dwordx4 v[164:167], v6, s[12:15], s28 offen sc0 sc1
    s_add_u32 s28, s33, 101376
    buffer_load_dwordx4 v[168:171], v6, s[12:15], s28 offen sc0 sc1
    s_add_u32 s28, s33, 12288
    buffer_load_dwordx4 v[172:175], v6, s[12:15], s28 offen sc0 sc1
    s_add_u32 s28, s33, 102400
    buffer_load_dwordx4 v[176:179], v6, s[12:15], s28 offen sc0 sc1
    s_add_u32 s28, s33, 13312
    buffer_load_dwordx4 v[180:183], v6, s[12:15], s28 offen sc0 sc1
    s_add_u32 s28, s33, 103424
    buffer_load_dwordx4 v[184:187], v6, s[12:15], s28 offen sc0 sc1
    ds_read_b64_tr_b16 v[188:189], v8 offset:0
    ds_read_b64_tr_b16 v[190:191], v8 offset:1024
    ds_read_b64_tr_b16 v[192:193], v9 offset:0
    ds_read_b64_tr_b16 v[194:195], v9 offset:1024
    s_waitcnt vmcnt(26)
    ds_read_b64_tr_b16 v[196:197], v8 offset:2048
    ds_read_b64_tr_b16 v[198:199], v8 offset:3072
    ds_read_b64_tr_b16 v[200:201], v9 offset:2048
    ds_read_b64_tr_b16 v[202:203], v9 offset:3072
    v_max3_u32 v3, v76, v77, v78
    v_max3_u32 v3, v3, v79, v80
    v_max3_u32 v3, v3, v81, v82
    v_max_u32 v3, v3, v83
    v_cmp_eq_u32 vcc, -1, v3
    s_cbranch_vccnz L_p23_kernel_ga0_fix
L_p23_kernel_ga0_ok:
    s_waitcnt lgkmcnt(4)
    v_mfma_f32_32x32x16_bf16 v[12:27], v[188:191], v[76:79], 0
    v_mfma_f32_32x32x16_bf16 v[28:43], v[188:191], v[80:83], 0
    v_mfma_f32_32x32x16_bf16 v[44:59], v[192:195], v[76:79], 0
    v_mfma_f32_32x32x16_bf16 v[60:75], v[192:195], v[80:83], 0
    s_add_u32 m0, s45, 0
    s_add_u32 s30, s47, 32768
    buffer_load_dwordx4 v7, s[56:59], s30 offen lds
    s_add_u32 m0, s45, 1024
    s_add_u32 s30, s47, 40960
    buffer_load_dwordx4 v7, s[56:59], s30 offen lds
    s_waitcnt vmcnt(26)
    ds_read_b64_tr_b16 v[188:189], v8 offset:4096
    ds_read_b64_tr_b16 v[190:191], v8 offset:5120
    ds_read_b64_tr_b16 v[192:193], v9 offset:4096
    ds_read_b64_tr_b16 v[194:195], v9 offset:5120
    v_max3_u32 v3, v84, v85, v86
    v_max3_u32 v3, v3, v87, v88
    v_max3_u32 v3, v3, v89, v90
    v_max_u32 v3, v3, v91
    v_cmp_eq_u32 vcc, -1, v3
    s_cbranch_vccnz L_p23_kernel_ga1_fix
L_p23_kernel_ga1_ok:
    s_waitcnt lgkmcnt(4)
    v_mfma_f32_32x32x16_bf16 v[12:27], v[196:199], v[84:87], v[12:27]
    v_mfma_f32_32x32x16_bf16 v[28:43], v[196:199], v[88:91], v[28:43]
    v_mfma_f32_32x32x16_bf16 v[44:59], v[200:203], v[84:87], v[44:59]
    v_mfma_f32_32x32x16_bf16 v[60:75], v[200:203], v[88:91], v[60:75]
    s_add_u32 m0, s45, 2048
    s_add_u32 s30, s47, 49152
    buffer_load_dwordx4 v7, s[56:59], s30 offen lds
    s_add_u32 m0, s45, 3072
    s_add_u32 s30, s47, 57344
    buffer_load_dwordx4 v7, s[56:59], s30 offen lds
    s_waitcnt vmcnt(26)
    ds_read_b64_tr_b16 v[196:197], v8 offset:6144
    ds_read_b64_tr_b16 v[198:199], v8 offset:7168
    ds_read_b64_tr_b16 v[200:201], v9 offset:6144
    ds_read_b64_tr_b16 v[202:203], v9 offset:7168
    v_max3_u32 v3, v92, v93, v94
    v_max3_u32 v3, v3, v95, v96
    v_max3_u32 v3, v3, v97, v98
    v_max_u32 v3, v3, v99
    v_cmp_eq_u32 vcc, -1, v3
    s_cbranch_vccnz L_p23_kernel_ga2_fix
L_p23_kernel_ga2_ok:
    s_waitcnt lgkmcnt(4)
    v_mfma_f32_32x32x16_bf16 v[12:27], v[188:191], v[92:95], v[12:27]
    v_mfma_f32_32x32x16_bf16 v[28:43], v[188:191], v[96:99], v[28:43]
    v_mfma_f32_32x32x16_bf16 v[44:59], v[192:195], v[92:95], v[44:59]
    v_mfma_f32_32x32x16_bf16 v[60:75], v[192:195], v[96:99], v[60:75]
    s_add_u32 m0, s45, 4096
    s_add_u32 s30, s47, 65536
    buffer_load_dwordx4 v7, s[56:59], s30 offen lds
    s_add_u32 m0, s45, 5120
    s_add_u32 s30, s47, 73728
    buffer_load_dwordx4 v7, s[56:59], s30 offen lds
    s_waitcnt vmcnt(26)
    ds_read_b64_tr_b16 v[188:189], v8 offset:8192
    ds_read_b64_tr_b16 v[190:191], v8 offset:9216
    ds_read_b64_tr_b16 v[192:193], v9 offset:8192
    ds_read_b64_tr_b16 v[194:195], v9 offset:9216
    v_max3_u32 v3, v100, v101, v102
    v_max3_u32 v3, v3, v103, v104
    v_max3_u32 v3, v3, v105, v106
    v_max_u32 v3, v3, v107
    v_cmp_eq_u32 vcc, -1, v3
    s_cbranch_vccnz L_p23_kernel_ga3_fix
L_p23_kernel_ga3_ok:
    s_waitcnt lgkmcnt(4)
    v_mfma_f32_32x32x16_bf16 v[12:27], v[196:199], v[100:103], v[12:27]
    v_mfma_f32_32x32x16_bf16 v[28:43], v[196:199], v[104:107], v[28:43]
    v_mfma_f32_32x32x16_bf16 v[44:59], v[200:203], v[100:103], v[44:59]
    v_mfma_f32_32x32x16_bf16 v[60:75], v[200:203], v[104:107], v[60:75]
    s_add_u32 m0, s45, 6144
    s_add_u32 s30, s47, 81920
    buffer_load_dwordx4 v7, s[56:59], s30 offen lds
    s_add_u32 m0, s45, 7168
    s_add_u32 s30, s47, 90112
    buffer_load_dwordx4 v7, s[56:59], s30 offen lds
    s_waitcnt vmcnt(26)
    ds_read_b64_tr_b16 v[196:197], v8 offset:10240
    ds_read_b64_tr_b16 v[198:199], v8 offset:11264
    ds_read_b64_tr_b16 v[200:201], v9 offset:10240
    ds_read_b64_tr_b16 v[202:203], v9 offset:11264
    v_max3_u32 v3, v108, v109, v110
    v_max3_u32 v3, v3, v111, v112
    v_max3_u32 v3, v3, v113, v114
    v_max_u32 v3, v3, v115
    v_cmp_eq_u32 vcc, -1, v3
    s_cbranch_vccnz L_p23_kernel_ga4_fix
L_p23_kernel_ga4_ok:
    s_waitcnt lgkmcnt(4)
    v_mfma_f32_32x32x16_bf16 v[12:27], v[188:191], v[108:111], v[12:27]
    v_mfma_f32_32x32x16_bf16 v[28:43], v[188:191], v[112:115], v[28:43]
    v_mfma_f32_32x32x16_bf16 v[44:59], v[192:195], v[108:111], v[44:59]
    v_mfma_f32_32x32x16_bf16 v[60:75], v[192:195], v[112:115], v[60:75]
    s_add_u32 m0, s45, 8192
    s_add_u32 s30, s47, 98304
    buffer_load_dwordx4 v7, s[56:59], s30 offen lds
    s_add_u32 m0, s45, 9216
    s_add_u32 s30, s47, 106496
    buffer_load_dwordx4 v7, s[56:59], s30 offen lds
    s_waitcnt vmcnt(26)
    ds_read_b64_tr_b16 v[188:189], v8 offset:12288
    ds_read_b64_tr_b16 v[190:191], v8 offset:13312
    ds_read_b64_tr_b16 v[192:193], v9 offset:12288
    ds_read_b64_tr_b16 v[194:195], v9 offset:13312
    v_max3_u32 v3, v116, v117, v118
    v_max3_u32 v3, v3, v119, v120
    v_max3_u32 v3, v3, v121, v122
    v_max_u32 v3, v3, v123
    v_cmp_eq_u32 vcc, -1, v3
    s_cbranch_vccnz L_p23_kernel_ga5_fix
L_p23_kernel_ga5_ok:
    s_waitcnt lgkmcnt(4)
    v_mfma_f32_32x32x16_bf16 v[12:27], v[196:199], v[116:119], v[12:27]
    v_mfma_f32_32x32x16_bf16 v[28:43], v[196:199], v[120:123], v[28:43]
    v_mfma_f32_32x32x16_bf16 v[44:59], v[200:203], v[116:119], v[44:59]
    v_mfma_f32_32x32x16_bf16 v[60:75], v[200:203], v[120:123], v[60:75]
    s_add_u32 m0, s45, 10240
    s_add_u32 s30, s47, 114688
    buffer_load_dwordx4 v7, s[56:59], s30 offen lds
    s_add_u32 m0, s45, 11264
    s_add_u32 s30, s47, 122880
    buffer_load_dwordx4 v7, s[56:59], s30 offen lds
    s_waitcnt vmcnt(26)
    ds_read_b64_tr_b16 v[196:197], v8 offset:14336
    ds_read_b64_tr_b16 v[198:199], v8 offset:15360
    ds_read_b64_tr_b16 v[200:201], v9 offset:14336
    ds_read_b64_tr_b16 v[202:203], v9 offset:15360
    v_max3_u32 v3, v124, v125, v126
    v_max3_u32 v3, v3, v127, v128
    v_max3_u32 v3, v3, v129, v130
    v_max_u32 v3, v3, v131
    v_cmp_eq_u32 vcc, -1, v3
    s_cbranch_vccnz L_p23_kernel_ga6_fix
L_p23_kernel_ga6_ok:
    s_waitcnt lgkmcnt(4)
    v_mfma_f32_32x32x16_bf16 v[12:27], v[188:191], v[124:127], v[12:27]
    v_mfma_f32_32x32x16_bf16 v[28:43], v[188:191], v[128:131], v[28:43]
    v_mfma_f32_32x32x16_bf16 v[44:59], v[192:195], v[124:127], v[44:59]
    v_mfma_f32_32x32x16_bf16 v[60:75], v[192:195], v[128:131], v[60:75]
    s_waitcnt vmcnt(24)
    ds_read_b64_tr_b16 v[188:189], v8 offset:16384
    ds_read_b64_tr_b16 v[190:191], v8 offset:17408
    ds_read_b64_tr_b16 v[192:193], v9 offset:16384
    ds_read_b64_tr_b16 v[194:195], v9 offset:17408
    v_max3_u32 v3, v132, v133, v134
    v_max3_u32 v3, v3, v135, v136
    v_max3_u32 v3, v3, v137, v138
    v_max_u32 v3, v3, v139
    v_cmp_eq_u32 vcc, -1, v3
    s_cbranch_vccnz L_p23_kernel_ga7_fix
L_p23_kernel_ga7_ok:
    s_waitcnt lgkmcnt(4)
    v_mfma_f32_32x32x16_bf16 v[12:27], v[196:199], v[132:135], v[12:27]
    v_mfma_f32_32x32x16_bf16 v[28:43], v[196:199], v[136:139], v[28:43]
    v_mfma_f32_32x32x16_bf16 v[44:59], v[200:203], v[132:135], v[44:59]
    v_mfma_f32_32x32x16_bf16 v[60:75], v[200:203], v[136:139], v[60:75]
    s_waitcnt vmcnt(22)
    ds_read_b64_tr_b16 v[196:197], v8 offset:18432
    ds_read_b64_tr_b16 v[198:199], v8 offset:19456
    ds_read_b64_tr_b16 v[200:201], v9 offset:18432
    ds_read_b64_tr_b16 v[202:203], v9 offset:19456
    v_max3_u32 v3, v140, v141, v142
    v_max3_u32 v3, v3, v143, v144
    v_max3_u32 v3, v3, v145, v146
    v_max_u32 v3, v3, v147
    v_cmp_eq_u32 vcc, -1, v3
    s_cbranch_vccnz L_p23_kernel_ga8_fix
L_p23_kernel_ga8_ok:
    s_waitcnt lgkmcnt(4)
    v_mfma_f32_32x32x16_bf16 v[12:27], v[188:191], v[140:143], v[12:27]
    v_mfma_f32_32x32x16_bf16 v[28:43], v[188:191], v[144:147], v[28:43]
    v_mfma_f32_32x32x16_bf16 v[44:59], v[192:195], v[140:143], v[44:59]
    v_mfma_f32_32x32x16_bf16 v[60:75], v[192:195], v[144:147], v[60:75]
    s_waitcnt vmcnt(20)
    ds_read_b64_tr_b16 v[188:189], v8 offset:20480
    ds_read_b64_tr_b16 v[190:191], v8 offset:21504
    ds_read_b64_tr_b16 v[192:193], v9 offset:20480
    ds_read_b64_tr_b16 v[194:195], v9 offset:21504
    v_max3_u32 v3, v148, v149, v150
    v_max3_u32 v3, v3, v151, v152
    v_max3_u32 v3, v3, v153, v154
    v_max_u32 v3, v3, v155
    v_cmp_eq_u32 vcc, -1, v3
    s_cbranch_vccnz L_p23_kernel_ga9_fix
L_p23_kernel_ga9_ok:
    s_waitcnt lgkmcnt(4)
    v_mfma_f32_32x32x16_bf16 v[12:27], v[196:199], v[148:151], v[12:27]
    v_mfma_f32_32x32x16_bf16 v[28:43], v[196:199], v[152:155], v[28:43]
    v_mfma_f32_32x32x16_bf16 v[44:59], v[200:203], v[148:151], v[44:59]
    v_mfma_f32_32x32x16_bf16 v[60:75], v[200:203], v[152:155], v[60:75]
    s_waitcnt vmcnt(18)
    ds_read_b64_tr_b16 v[196:197], v8 offset:22528
    ds_read_b64_tr_b16 v[198:199], v8 offset:23552
    ds_read_b64_tr_b16 v[200:201], v9 offset:22528
    ds_read_b64_tr_b16 v[202:203], v9 offset:23552
    v_max3_u32 v3, v156, v157, v158
    v_max3_u32 v3, v3, v159, v160
    v_max3_u32 v3, v3, v161, v162
    v_max_u32 v3, v3, v163
    v_cmp_eq_u32 vcc, -1, v3
    s_cbranch_vccnz L_p23_kernel_ga10_fix
L_p23_kernel_ga10_ok:
    s_waitcnt lgkmcnt(4)
    v_mfma_f32_32x32x16_bf16 v[12:27], v[188:191], v[156:159], v[12:27]
    v_mfma_f32_32x32x16_bf16 v[28:43], v[188:191], v[160:163], v[28:43]
    v_mfma_f32_32x32x16_bf16 v[44:59], v[192:195], v[156:159], v[44:59]
    v_mfma_f32_32x32x16_bf16 v[60:75], v[192:195], v[160:163], v[60:75]
    s_waitcnt vmcnt(16)
    ds_read_b64_tr_b16 v[188:189], v11 offset:0
    ds_read_b64_tr_b16 v[190:191], v11 offset:1024
    ds_read_b64_tr_b16 v[192:193], v236 offset:0
    ds_read_b64_tr_b16 v[194:195], v236 offset:1024
    v_max3_u32 v3, v164, v165, v166
    v_max3_u32 v3, v3, v167, v168
    v_max3_u32 v3, v3, v169, v170
    v_max_u32 v3, v3, v171
    v_cmp_eq_u32 vcc, -1, v3
    s_cbranch_vccnz L_p23_kernel_ga11_fix
L_p23_kernel_ga11_ok:
    s_waitcnt lgkmcnt(4)
    v_mfma_f32_32x32x16_bf16 v[12:27], v[196:199], v[164:167], v[12:27]
    v_mfma_f32_32x32x16_bf16 v[28:43], v[196:199], v[168:171], v[28:43]
    v_mfma_f32_32x32x16_bf16 v[44:59], v[200:203], v[164:167], v[44:59]
    v_mfma_f32_32x32x16_bf16 v[60:75], v[200:203], v[168:171], v[60:75]
    s_waitcnt vmcnt(14)
    ds_read_b64_tr_b16 v[196:197], v11 offset:2048
    ds_read_b64_tr_b16 v[198:199], v11 offset:3072
    ds_read_b64_tr_b16 v[200:201], v236 offset:2048
    ds_read_b64_tr_b16 v[202:203], v236 offset:3072
    v_max3_u32 v3, v172, v173, v174
    v_max3_u32 v3, v3, v175, v176
    v_max3_u32 v3, v3, v177, v178
    v_max_u32 v3, v3, v179
    v_cmp_eq_u32 vcc, -1, v3
    s_cbranch_vccnz L_p23_kernel_ga12_fix
L_p23_kernel_ga12_ok:
    s_waitcnt lgkmcnt(4)
    v_mfma_f32_32x32x16_bf16 v[12:27], v[188:191], v[172:175], v[12:27]
    v_mfma_f32_32x32x16_bf16 v[28:43], v[188:191], v[176:179], v[28:43]
    v_mfma_f32_32x32x16_bf16 v[44:59], v[192:195], v[172:175], v[44:59]
    v_mfma_f32_32x32x16_bf16 v[60:75], v[192:195], v[176:179], v[60:75]
    s_waitcnt vmcnt(12)
    v_max3_u32 v3, v180, v181, v182
    v_max3_u32 v3, v3, v183, v184
    v_max3_u32 v3, v3, v185, v186
    v_max_u32 v3, v3, v187
    v_cmp_eq_u32 vcc, -1, v3
    s_cbranch_vccnz L_p23_kernel_ga13_fix
L_p23_kernel_ga13_ok:
    s_waitcnt lgkmcnt(0)
    v_mfma_f32_32x32x16_bf16 v[12:27], v[196:199], v[180:183], v[12:27]
    v_mfma_f32_32x32x16_bf16 v[28:43], v[196:199], v[184:187], v[28:43]
    v_mfma_f32_32x32x16_bf16 v[44:59], v[200:203], v[180:183], v[44:59]
    v_mfma_f32_32x32x16_bf16 v[60:75], v[200:203], v[184:187], v[60:75]
    v_and_b32 v4, 1, v1
    v_mul_u32_u24 v4, 88, v4
    v_and_b32 v5, 6, v1
    v_add_u32 v4, v4, v5
    s_lshl_b32 s28, s27, 3
    s_add_u32 s28, s28, 1
    v_add_u32 v4, s28, v4
    v_lshlrev_b32 v5, 10, v4
    s_mov_b32 s36, 1048576
L_p23_kernel_po:
    buffer_load_dword v3, v5, s[12:15], s32 offen sc0 sc1
    s_waitcnt vmcnt(0)
    v_cmp_eq_u32 vcc, -1, v3
    s_sub_u32 s36, s36, 1
    s_cbranch_vccz L_p23_kernel_pook
    s_cmp_eq_u32 s36, 0
    s_cbranch_scc1 L_p23_kernel_pook
    s_sleep 1
    s_branch L_p23_kernel_po
L_p23_kernel_pook:
    s_mul_i32 s33, s27, 8192
    s_add_u32 s33, s33, s32
    s_add_u32 s28, s33, 0
    buffer_load_dwordx4 v[76:79], v6, s[12:15], s28 offen sc0 sc1
    s_add_u32 s28, s33, 90112
    buffer_load_dwordx4 v[80:83], v6, s[12:15], s28 offen sc0 sc1
    s_add_u32 s28, s33, 1024
    buffer_load_dwordx4 v[84:87], v6, s[12:15], s28 offen sc0 sc1
    s_add_u32 s28, s33, 91136
    buffer_load_dwordx4 v[88:91], v6, s[12:15], s28 offen sc0 sc1
    s_add_u32 s28, s33, 2048
    buffer_load_dwordx4 v[92:95], v6, s[12:15], s28 offen sc0 sc1
    s_add_u32 s28, s33, 92160
    buffer_load_dwordx4 v[96:99], v6, s[12:15], s28 offen sc0 sc1
    s_add_u32 s28, s33, 3072
    buffer_load_dwordx4 v[100:103], v6, s[12:15], s28 offen sc0 sc1
    s_add_u32 s28, s33, 93184
    buffer_load_dwordx4 v[104:107], v6, s[12:15], s28 offen sc0 sc1
    s_add_u32 s28, s33, 4096
    buffer_load_dwordx4 v[108:111], v6, s[12:15], s28 offen sc0 sc1
    s_add_u32 s28, s33, 94208
    buffer_load_dwordx4 v[112:115], v6, s[12:15], s28 offen sc0 sc1
    s_add_u32 s28, s33, 5120
    buffer_load_dwordx4 v[116:119], v6, s[12:15], s28 offen sc0 sc1
    s_add_u32 s28, s33, 95232
    buffer_load_dwordx4 v[120:123], v6, s[12:15], s28 offen sc0 sc1
    s_add_u32 s28, s33, 6144
    buffer_load_dwordx4 v[124:127], v6, s[12:15], s28 offen sc0 sc1
    s_add_u32 s28, s33, 96256
    buffer_load_dwordx4 v[128:131], v6, s[12:15], s28 offen sc0 sc1
    s_add_u32 s28, s33, 7168
    buffer_load_dwordx4 v[132:135], v6, s[12:15], s28 offen sc0 sc1
    s_add_u32 s28, s33, 97280
    buffer_load_dwordx4 v[136:139], v6, s[12:15], s28 offen sc0 sc1
    ds_read_b64_tr_b16 v[188:189], v11 offset:4096
    ds_read_b64_tr_b16 v[190:191], v11 offset:5120
    ds_read_b64_tr_b16 v[192:193], v236 offset:4096
    ds_read_b64_tr_b16 v[194:195], v236 offset:5120
    s_waitcnt vmcnt(14)
    ds_read_b64_tr_b16 v[196:197], v11 offset:6144
    ds_read_b64_tr_b16 v[198:199], v11 offset:7168
    ds_read_b64_tr_b16 v[200:201], v236 offset:6144
    ds_read_b64_tr_b16 v[202:203], v236 offset:7168
    v_max3_u32 v3, v76, v77, v78
    v_max3_u32 v3, v3, v79, v80
    v_max3_u32 v3, v3, v81, v82
    v_max_u32 v3, v3, v83
    v_cmp_eq_u32 vcc, -1, v3
    s_cbranch_vccnz L_p23_kernel_go0_fix
L_p23_kernel_go0_ok:
    s_waitcnt lgkmcnt(4)
    v_mfma_f32_32x32x16_bf16 v[12:27], v[188:191], v[76:79], v[12:27]
    v_mfma_f32_32x32x16_bf16 v[28:43], v[188:191], v[80:83], v[28:43]
    v_mfma_f32_32x32x16_bf16 v[44:59], v[192:195], v[76:79], v[44:59]
    v_mfma_f32_32x32x16_bf16 v[60:75], v[192:195], v[80:83], v[60:75]
    s_waitcnt vmcnt(12)
    ds_read_b64_tr_b16 v[188:189], v8 offset:0
    ds_read_b64_tr_b16 v[190:191], v8 offset:1024
    ds_read_b64_tr_b16 v[192:193], v9 offset:0
    ds_read_b64_tr_b16 v[194:195], v9 offset:1024
    v_max3_u32 v3, v84, v85, v86
    v_max3_u32 v3, v3, v87, v88
    v_max3_u32 v3, v3, v89, v90
    v_max_u32 v3, v3, v91
    v_cmp_eq_u32 vcc, -1, v3
    s_cbranch_vccnz L_p23_kernel_go1_fix
L_p23_kernel_go1_ok:
    s_waitcnt lgkmcnt(4)
    v_mfma_f32_32x32x16_bf16 v[12:27], v[196:199], v[84:87], v[12:27]
    v_mfma_f32_32x32x16_bf16 v[28:43], v[196:199], v[88:91], v[28:43]
    v_mfma_f32_32x32x16_bf16 v[44:59], v[200:203], v[84:87], v[44:59]
    v_mfma_f32_32x32x16_bf16 v[60:75], v[200:203], v[88:91], v[60:75]
    s_waitcnt vmcnt(10)
    ds_read_b64_tr_b16 v[196:197], v8 offset:2048
    ds_read_b64_tr_b16 v[198:199], v8 offset:3072
    ds_read_b64_tr_b16 v[200:201], v9 offset:2048
    ds_read_b64_tr_b16 v[202:203], v9 offset:3072
    v_max3_u32 v3, v92, v93, v94
    v_max3_u32 v3, v3, v95, v96
    v_max3_u32 v3, v3, v97, v98
    v_max_u32 v3, v3, v99
    v_cmp_eq_u32 vcc, -1, v3
    s_cbranch_vccnz L_p23_kernel_go2_fix
L_p23_kernel_go2_ok:
    s_waitcnt lgkmcnt(4)
    v_mfma_f32_32x32x16_bf16 v[12:27], v[188:191], v[92:95], v[12:27]
    v_mfma_f32_32x32x16_bf16 v[28:43], v[188:191], v[96:99], v[28:43]
    v_mfma_f32_32x32x16_bf16 v[44:59], v[192:195], v[92:95], v[44:59]
    v_mfma_f32_32x32x16_bf16 v[60:75], v[192:195], v[96:99], v[60:75]
    s_waitcnt vmcnt(8)
    ds_read_b64_tr_b16 v[188:189], v8 offset:4096
    ds_read_b64_tr_b16 v[190:191], v8 offset:5120
    ds_read_b64_tr_b16 v[192:193], v9 offset:4096
    ds_read_b64_tr_b16 v[194:195], v9 offset:5120
    v_max3_u32 v3, v100, v101, v102
    v_max3_u32 v3, v3, v103, v104
    v_max3_u32 v3, v3, v105, v106
    v_max_u32 v3, v3, v107
    v_cmp_eq_u32 vcc, -1, v3
    s_cbranch_vccnz L_p23_kernel_go3_fix
L_p23_kernel_go3_ok:
    s_waitcnt lgkmcnt(4)
    v_mfma_f32_32x32x16_bf16 v[12:27], v[196:199], v[100:103], v[12:27]
    v_mfma_f32_32x32x16_bf16 v[28:43], v[196:199], v[104:107], v[28:43]
    v_mfma_f32_32x32x16_bf16 v[44:59], v[200:203], v[100:103], v[44:59]
    v_mfma_f32_32x32x16_bf16 v[60:75], v[200:203], v[104:107], v[60:75]
    s_waitcnt vmcnt(6)
    ds_read_b64_tr_b16 v[196:197], v8 offset:6144
    ds_read_b64_tr_b16 v[198:199], v8 offset:7168
    ds_read_b64_tr_b16 v[200:201], v9 offset:6144
    ds_read_b64_tr_b16 v[202:203], v9 offset:7168
    v_max3_u32 v3, v108, v109, v110
    v_max3_u32 v3, v3, v111, v112
    v_max3_u32 v3, v3, v113, v114
    v_max_u32 v3, v3, v115
    v_cmp_eq_u32 vcc, -1, v3
    s_cbranch_vccnz L_p23_kernel_go4_fix
L_p23_kernel_go4_ok:
    s_waitcnt lgkmcnt(4)
    v_mfma_f32_32x32x16_bf16 v[12:27], v[188:191], v[108:111], v[12:27]
    v_mfma_f32_32x32x16_bf16 v[28:43], v[188:191], v[112:115], v[28:43]
    v_mfma_f32_32x32x16_bf16 v[44:59], v[192:195], v[108:111], v[44:59]
    v_mfma_f32_32x32x16_bf16 v[60:75], v[192:195], v[112:115], v[60:75]
    s_waitcnt vmcnt(4)
    ds_read_b64_tr_b16 v[188:189], v8 offset:8192
    ds_read_b64_tr_b16 v[190:191], v8 offset:9216
    ds_read_b64_tr_b16 v[192:193], v9 offset:8192
    ds_read_b64_tr_b16 v[194:195], v9 offset:9216
    v_max3_u32 v3, v116, v117, v118
    v_max3_u32 v3, v3, v119, v120
    v_max3_u32 v3, v3, v121, v122
    v_max_u32 v3, v3, v123
    v_cmp_eq_u32 vcc, -1, v3
    s_cbranch_vccnz L_p23_kernel_go5_fix
L_p23_kernel_go5_ok:
    s_waitcnt lgkmcnt(4)
    v_mfma_f32_32x32x16_bf16 v[12:27], v[196:199], v[116:119], v[12:27]
    v_mfma_f32_32x32x16_bf16 v[28:43], v[196:199], v[120:123], v[28:43]
    v_mfma_f32_32x32x16_bf16 v[44:59], v[200:203], v[116:119], v[44:59]
    v_mfma_f32_32x32x16_bf16 v[60:75], v[200:203], v[120:123], v[60:75]
    s_waitcnt vmcnt(2)
    ds_read_b64_tr_b16 v[196:197], v8 offset:10240
    ds_read_b64_tr_b16 v[198:199], v8 offset:11264
    ds_read_b64_tr_b16 v[200:201], v9 offset:10240
    ds_read_b64_tr_b16 v[202:203], v9 offset:11264
    v_max3_u32 v3, v124, v125, v126
    v_max3_u32 v3, v3, v127, v128
    v_max3_u32 v3, v3, v129, v130
    v_max_u32 v3, v3, v131
    v_cmp_eq_u32 vcc, -1, v3
    s_cbranch_vccnz L_p23_kernel_go6_fix
L_p23_kernel_go6_ok:
    s_waitcnt lgkmcnt(4)
    v_mfma_f32_32x32x16_bf16 v[12:27], v[188:191], v[124:127], v[12:27]
    v_mfma_f32_32x32x16_bf16 v[28:43], v[188:191], v[128:131], v[28:43]
    v_mfma_f32_32x32x16_bf16 v[44:59], v[192:195], v[124:127], v[44:59]
    v_mfma_f32_32x32x16_bf16 v[60:75], v[192:195], v[128:131], v[60:75]
    s_waitcnt vmcnt(0)
    v_max3_u32 v3, v132, v133, v134
    v_max3_u32 v3, v3, v135, v136
    v_max3_u32 v3, v3, v137, v138
    v_max_u32 v3, v3, v139
    v_cmp_eq_u32 vcc, -1, v3
    s_cbranch_vccnz L_p23_kernel_go7_fix
L_p23_kernel_go7_ok:
    s_waitcnt lgkmcnt(0)
    v_mfma_f32_32x32x16_bf16 v[12:27], v[196:199], v[132:135], v[12:27]
    v_mfma_f32_32x32x16_bf16 v[28:43], v[196:199], v[136:139], v[28:43]
    v_mfma_f32_32x32x16_bf16 v[44:59], v[200:203], v[132:135], v[44:59]
    v_mfma_f32_32x32x16_bf16 v[60:75], v[200:203], v[136:139], v[60:75]
    s_nop 11
    v_and_b32 v2, 31, v1
    v_mul_u32_u24 v2, 272, v2
    v_lshrrev_b32 v3, 5, v1
    v_lshlrev_b32 v3, 4, v3
    v_add_u32 v2, v2, v3
    v_add_u32 v2, s45, v2
    ds_write_b128 v2, v[12:15] offset:0
    ds_write_b128 v2, v[16:19] offset:32
    ds_write_b128 v2, v[20:23] offset:64
    ds_write_b128 v2, v[24:27] offset:96
    ds_write_b128 v2, v[28:31] offset:8704
    ds_write_b128 v2, v[32:35] offset:8736
    ds_write_b128 v2, v[36:39] offset:8768
    ds_write_b128 v2, v[40:43] offset:8800
    ds_write_b128 v2, v[44:47] offset:128
    ds_write_b128 v2, v[48:51] offset:160
    ds_write_b128 v2, v[52:55] offset:192
    ds_write_b128 v2, v[56:59] offset:224
    ds_write_b128 v2, v[60:63] offset:8832
    ds_write_b128 v2, v[64:67] offset:8864
    ds_write_b128 v2, v[68:71] offset:8896
    ds_write_b128 v2, v[72:75] offset:8928
L_p23_kernel_red:
    s_setprio 0
    v_lshrrev_b32 v2, 3, v0
    v_mul_u32_u24 v2, 272, v2
    v_and_b32 v3, 7, v0
    v_lshlrev_b32 v3, 5, v3
    v_add_u32 v2, v2, v3
    v_add_u32 v3, 65536, v2
    s_waitcnt lgkmcnt(0)
    s_barrier
    ds_read_b128 v[76:79], v2 offset:0
    ds_read_b128 v[80:83], v2 offset:16
    ds_read_b128 v[84:87], v2 offset:24576
    ds_read_b128 v[88:91], v2 offset:24592
    ds_read_b128 v[92:95], v3 offset:0
    ds_read_b128 v[96:99], v3 offset:16
    ds_read_b128 v[100:103], v3 offset:24576
    ds_read_b128 v[104:107], v3 offset:24592
    s_waitcnt lgkmcnt(0) vmcnt(0)
    v_pk_add_f32 v[76:77], v[76:77], v[92:93]
    v_pk_add_f32 v[78:79], v[78:79], v[94:95]
    v_pk_add_f32 v[80:81], v[80:81], v[96:97]
    v_pk_add_f32 v[82:83], v[82:83], v[98:99]
    v_pk_add_f32 v[84:85], v[84:85], v[100:101]
    v_pk_add_f32 v[86:87], v[86:87], v[102:103]
    v_pk_add_f32 v[88:89], v[88:89], v[104:105]
    v_pk_add_f32 v[90:91], v[90:91], v[106:107]
    v_pk_add_f32 v[76:77], v[76:77], v[84:85]
    v_pk_add_f32 v[78:79], v[78:79], v[86:87]
    v_pk_add_f32 v[80:81], v[80:81], v[88:89]
    v_pk_add_f32 v[82:83], v[82:83], v[90:91]
    v_lshlrev_b32 v2, 16, v220
    v_and_b32 v3, 0xffff0000, v220
    v_add_f32 v2, v2, v76
    v_add_f32 v3, v3, v77
    v_cvt_pk_bf16_f32 v220, v2, v3
    v_lshlrev_b32 v2, 16, v221
    v_and_b32 v3, 0xffff0000, v221
    v_add_f32 v2, v2, v78
    v_add_f32 v3, v3, v79
    v_cvt_pk_bf16_f32 v221, v2, v3
    v_lshlrev_b32 v2, 16, v222
    v_and_b32 v3, 0xffff0000, v222
    v_add_f32 v2, v2, v80
    v_add_f32 v3, v3, v81
    v_cvt_pk_bf16_f32 v222, v2, v3
    v_lshlrev_b32 v2, 16, v223
    v_and_b32 v3, 0xffff0000, v223
    v_add_f32 v2, v2, v82
    v_add_f32 v3, v3, v83
    v_cvt_pk_bf16_f32 v223, v2, v3
    buffer_store_dwordx4 v[220:223], v224, s[52:55], 0 offen sc1
    s_waitcnt vmcnt(0)
L_p23_kernel_tailend:
L_p23_kernel_end:
    s_endpgm
L_p23_kernel_ga0_fix:
    s_mov_b32 s36, 1048576
L_p23_kernel_ga0_rt:
    s_add_u32 s28, s33, 0
    buffer_load_dwordx4 v[76:79], v6, s[12:15], s28 offen sc0 sc1
    s_add_u32 s28, s33, 90112
    buffer_load_dwordx4 v[80:83], v6, s[12:15], s28 offen sc0 sc1
    s_add_u32 s28, s33, 1024
    buffer_load_dwordx4 v[84:87], v6, s[12:15], s28 offen sc0 sc1
    s_add_u32 s28, s33, 91136
    buffer_load_dwordx4 v[88:91], v6, s[12:15], s28 offen sc0 sc1
    s_add_u32 s28, s33, 2048
    buffer_load_dwordx4 v[92:95], v6, s[12:15], s28 offen sc0 sc1
    s_add_u32 s28, s33, 92160
    buffer_load_dwordx4 v[96:99], v6, s[12:15], s28 offen sc0 sc1
    s_add_u32 s28, s33, 3072
    buffer_load_dwordx4 v[100:103], v6, s[12:15], s28 offen sc0 sc1
    s_add_u32 s28, s33, 93184
    buffer_load_dwordx4 v[104:107], v6, s[12:15], s28 offen sc0 sc1
    s_add_u32 s28, s33, 4096
    buffer_load_dwordx4 v[108:111], v6, s[12:15], s28 offen sc0 sc1
    s_add_u32 s28, s33, 94208
    buffer_load_dwordx4 v[112:115], v6, s[12:15], s28 offen sc0 sc1
    s_add_u32 s28, s33, 5120
    buffer_load_dwordx4 v[116:119], v6, s[12:15], s28 offen sc0 sc1
    s_add_u32 s28, s33, 95232
    buffer_load_dwordx4 v[120:123], v6, s[12:15], s28 offen sc0 sc1
    s_add_u32 s28, s33, 6144
    buffer_load_dwordx4 v[124:127], v6, s[12:15], s28 offen sc0 sc1
    s_add_u32 s28, s33, 96256
    buffer_load_dwordx4 v[128:131], v6, s[12:15], s28 offen sc0 sc1
    s_add_u32 s28, s33, 7168
    buffer_load_dwordx4 v[132:135], v6, s[12:15], s28 offen sc0 sc1
    s_add_u32 s28, s33, 97280
    buffer_load_dwordx4 v[136:139], v6, s[12:15], s28 offen sc0 sc1
    s_add_u32 s28, s33, 8192
    buffer_load_dwordx4 v[140:143], v6, s[12:15], s28 offen sc0 sc1
    s_add_u32 s28, s33, 98304
    buffer_load_dwordx4 v[144:147], v6, s[12:15], s28 offen sc0 sc1
    s_add_u32 s28, s33, 9216
    buffer_load_dwordx4 v[148:151], v6, s[12:15], s28 offen sc0 sc1
    s_add_u32 s28, s33, 99328
    buffer_load_dwordx4 v[152:155], v6, s[12:15], s28 offen sc0 sc1
    s_add_u32 s28, s33, 10240
    buffer_load_dwordx4 v[156:159], v6, s[12:15], s28 offen sc0 sc1
    s_add_u32 s28, s33, 100352
    buffer_load_dwordx4 v[160:163], v6, s[12:15], s28 offen sc0 sc1
    s_add_u32 s28, s33, 11264
    buffer_load_dwordx4 v[164:167], v6, s[12:15], s28 offen sc0 sc1
    s_add_u32 s28, s33, 101376
    buffer_load_dwordx4 v[168:171], v6, s[12:15], s28 offen sc0 sc1
    s_add_u32 s28, s33, 12288
    buffer_load_dwordx4 v[172:175], v6, s[12:15], s28 offen sc0 sc1
    s_add_u32 s28, s33, 102400
    buffer_load_dwordx4 v[176:179], v6, s[12:15], s28 offen sc0 sc1
    s_add_u32 s28, s33, 13312
    buffer_load_dwordx4 v[180:183], v6, s[12:15], s28 offen sc0 sc1
    s_add_u32 s28, s33, 103424
    buffer_load_dwordx4 v[184:187], v6, s[12:15], s28 offen sc0 sc1
    s_waitcnt vmcnt(0)
    v_max3_u32 v3, v76, v77, v78
    v_max3_u32 v3, v3, v79, v80
    v_max3_u32 v3, v3, v81, v82
    v_max_u32 v3, v3, v83
    v_cmp_eq_u32 vcc, -1, v3
    s_sub_u32 s36, s36, 1
    s_cbranch_vccz L_p23_kernel_ga0_ok
    s_cmp_eq_u32 s36, 0
    s_cbranch_scc0 L_p23_kernel_ga0_rt
    s_branch L_p23_kernel_ga0_ok
L_p23_kernel_ga1_fix:
    s_mov_b32 s36, 1048576
L_p23_kernel_ga1_rt:
    s_add_u32 s28, s33, 1024
    buffer_load_dwordx4 v[84:87], v6, s[12:15], s28 offen sc0 sc1
    s_add_u32 s28, s33, 91136
    buffer_load_dwordx4 v[88:91], v6, s[12:15], s28 offen sc0 sc1
    s_add_u32 s28, s33, 2048
    buffer_load_dwordx4 v[92:95], v6, s[12:15], s28 offen sc0 sc1
    s_add_u32 s28, s33, 92160
    buffer_load_dwordx4 v[96:99], v6, s[12:15], s28 offen sc0 sc1
    s_add_u32 s28, s33, 3072
    buffer_load_dwordx4 v[100:103], v6, s[12:15], s28 offen sc0 sc1
    s_add_u32 s28, s33, 93184
    buffer_load_dwordx4 v[104:107], v6, s[12:15], s28 offen sc0 sc1
    s_add_u32 s28, s33, 4096
    buffer_load_dwordx4 v[108:111], v6, s[12:15], s28 offen sc0 sc1
    s_add_u32 s28, s33, 94208
    buffer_load_dwordx4 v[112:115], v6, s[12:15], s28 offen sc0 sc1
    s_add_u32 s28, s33, 5120
    buffer_load_dwordx4 v[116:119], v6, s[12:15], s28 offen sc0 sc1
    s_add_u32 s28, s33, 95232
    buffer_load_dwordx4 v[120:123], v6, s[12:15], s28 offen sc0 sc1
    s_add_u32 s28, s33, 6144
    buffer_load_dwordx4 v[124:127], v6, s[12:15], s28 offen sc0 sc1
    s_add_u32 s28, s33, 96256
    buffer_load_dwordx4 v[128:131], v6, s[12:15], s28 offen sc0 sc1
    s_add_u32 s28, s33, 7168
    buffer_load_dwordx4 v[132:135], v6, s[12:15], s28 offen sc0 sc1
    s_add_u32 s28, s33, 97280
    buffer_load_dwordx4 v[136:139], v6, s[12:15], s28 offen sc0 sc1
    s_add_u32 s28, s33, 8192
    buffer_load_dwordx4 v[140:143], v6, s[12:15], s28 offen sc0 sc1
    s_add_u32 s28, s33, 98304
    buffer_load_dwordx4 v[144:147], v6, s[12:15], s28 offen sc0 sc1
    s_add_u32 s28, s33, 9216
    buffer_load_dwordx4 v[148:151], v6, s[12:15], s28 offen sc0 sc1
    s_add_u32 s28, s33, 99328
    buffer_load_dwordx4 v[152:155], v6, s[12:15], s28 offen sc0 sc1
    s_add_u32 s28, s33, 10240
    buffer_load_dwordx4 v[156:159], v6, s[12:15], s28 offen sc0 sc1
    s_add_u32 s28, s33, 100352
    buffer_load_dwordx4 v[160:163], v6, s[12:15], s28 offen sc0 sc1
    s_add_u32 s28, s33, 11264
    buffer_load_dwordx4 v[164:167], v6, s[12:15], s28 offen sc0 sc1
    s_add_u32 s28, s33, 101376
    buffer_load_dwordx4 v[168:171], v6, s[12:15], s28 offen sc0 sc1
    s_add_u32 s28, s33, 12288
    buffer_load_dwordx4 v[172:175], v6, s[12:15], s28 offen sc0 sc1
    s_add_u32 s28, s33, 102400
    buffer_load_dwordx4 v[176:179], v6, s[12:15], s28 offen sc0 sc1
    s_add_u32 s28, s33, 13312
    buffer_load_dwordx4 v[180:183], v6, s[12:15], s28 offen sc0 sc1
    s_add_u32 s28, s33, 103424
    buffer_load_dwordx4 v[184:187], v6, s[12:15], s28 offen sc0 sc1
    s_waitcnt vmcnt(0)
    v_max3_u32 v3, v84, v85, v86
    v_max3_u32 v3, v3, v87, v88
    v_max3_u32 v3, v3, v89, v90
    v_max_u32 v3, v3, v91
    v_cmp_eq_u32 vcc, -1, v3
    s_sub_u32 s36, s36, 1
    s_cbranch_vccz L_p23_kernel_ga1_ok
    s_cmp_eq_u32 s36, 0
    s_cbranch_scc0 L_p23_kernel_ga1_rt
    s_branch L_p23_kernel_ga1_ok
L_p23_kernel_ga2_fix:
    s_mov_b32 s36, 1048576
L_p23_kernel_ga2_rt:
    s_add_u32 s28, s33, 2048
    buffer_load_dwordx4 v[92:95], v6, s[12:15], s28 offen sc0 sc1
    s_add_u32 s28, s33, 92160
    buffer_load_dwordx4 v[96:99], v6, s[12:15], s28 offen sc0 sc1
    s_add_u32 s28, s33, 3072
    buffer_load_dwordx4 v[100:103], v6, s[12:15], s28 offen sc0 sc1
    s_add_u32 s28, s33, 93184
    buffer_load_dwordx4 v[104:107], v6, s[12:15], s28 offen sc0 sc1
    s_add_u32 s28, s33, 4096
    buffer_load_dwordx4 v[108:111], v6, s[12:15], s28 offen sc0 sc1
    s_add_u32 s28, s33, 94208
    buffer_load_dwordx4 v[112:115], v6, s[12:15], s28 offen sc0 sc1
    s_add_u32 s28, s33, 5120
    buffer_load_dwordx4 v[116:119], v6, s[12:15], s28 offen sc0 sc1
    s_add_u32 s28, s33, 95232
    buffer_load_dwordx4 v[120:123], v6, s[12:15], s28 offen sc0 sc1
    s_add_u32 s28, s33, 6144
    buffer_load_dwordx4 v[124:127], v6, s[12:15], s28 offen sc0 sc1
    s_add_u32 s28, s33, 96256
    buffer_load_dwordx4 v[128:131], v6, s[12:15], s28 offen sc0 sc1
    s_add_u32 s28, s33, 7168
    buffer_load_dwordx4 v[132:135], v6, s[12:15], s28 offen sc0 sc1
    s_add_u32 s28, s33, 97280
    buffer_load_dwordx4 v[136:139], v6, s[12:15], s28 offen sc0 sc1
    s_add_u32 s28, s33, 8192
    buffer_load_dwordx4 v[140:143], v6, s[12:15], s28 offen sc0 sc1
    s_add_u32 s28, s33, 98304
    buffer_load_dwordx4 v[144:147], v6, s[12:15], s28 offen sc0 sc1
    s_add_u32 s28, s33, 9216
    buffer_load_dwordx4 v[148:151], v6, s[12:15], s28 offen sc0 sc1
    s_add_u32 s28, s33, 99328
    buffer_load_dwordx4 v[152:155], v6, s[12:15], s28 offen sc0 sc1
    s_add_u32 s28, s33, 10240
    buffer_load_dwordx4 v[156:159], v6, s[12:15], s28 offen sc0 sc1
    s_add_u32 s28, s33, 100352
    buffer_load_dwordx4 v[160:163], v6, s[12:15], s28 offen sc0 sc1
    s_add_u32 s28, s33, 11264
    buffer_load_dwordx4 v[164:167], v6, s[12:15], s28 offen sc0 sc1
    s_add_u32 s28, s33, 101376
    buffer_load_dwordx4 v[168:171], v6, s[12:15], s28 offen sc0 sc1
    s_add_u32 s28, s33, 12288
    buffer_load_dwordx4 v[172:175], v6, s[12:15], s28 offen sc0 sc1
    s_add_u32 s28, s33, 102400
    buffer_load_dwordx4 v[176:179], v6, s[12:15], s28 offen sc0 sc1
    s_add_u32 s28, s33, 13312
    buffer_load_dwordx4 v[180:183], v6, s[12:15], s28 offen sc0 sc1
    s_add_u32 s28, s33, 103424
    buffer_load_dwordx4 v[184:187], v6, s[12:15], s28 offen sc0 sc1
    s_waitcnt vmcnt(0)
    v_max3_u32 v3, v92, v93, v94
    v_max3_u32 v3, v3, v95, v96
    v_max3_u32 v3, v3, v97, v98
    v_max_u32 v3, v3, v99
    v_cmp_eq_u32 vcc, -1, v3
    s_sub_u32 s36, s36, 1
    s_cbranch_vccz L_p23_kernel_ga2_ok
    s_cmp_eq_u32 s36, 0
    s_cbranch_scc0 L_p23_kernel_ga2_rt
    s_branch L_p23_kernel_ga2_ok
L_p23_kernel_ga3_fix:
    s_mov_b32 s36, 1048576
L_p23_kernel_ga3_rt:
    s_add_u32 s28, s33, 3072
    buffer_load_dwordx4 v[100:103], v6, s[12:15], s28 offen sc0 sc1
    s_add_u32 s28, s33, 93184
    buffer_load_dwordx4 v[104:107], v6, s[12:15], s28 offen sc0 sc1
    s_add_u32 s28, s33, 4096
    buffer_load_dwordx4 v[108:111], v6, s[12:15], s28 offen sc0 sc1
    s_add_u32 s28, s33, 94208
    buffer_load_dwordx4 v[112:115], v6, s[12:15], s28 offen sc0 sc1
    s_add_u32 s28, s33, 5120
    buffer_load_dwordx4 v[116:119], v6, s[12:15], s28 offen sc0 sc1
    s_add_u32 s28, s33, 95232
    buffer_load_dwordx4 v[120:123], v6, s[12:15], s28 offen sc0 sc1
    s_add_u32 s28, s33, 6144
    buffer_load_dwordx4 v[124:127], v6, s[12:15], s28 offen sc0 sc1
    s_add_u32 s28, s33, 96256
    buffer_load_dwordx4 v[128:131], v6, s[12:15], s28 offen sc0 sc1
    s_add_u32 s28, s33, 7168
    buffer_load_dwordx4 v[132:135], v6, s[12:15], s28 offen sc0 sc1
    s_add_u32 s28, s33, 97280
    buffer_load_dwordx4 v[136:139], v6, s[12:15], s28 offen sc0 sc1
    s_add_u32 s28, s33, 8192
    buffer_load_dwordx4 v[140:143], v6, s[12:15], s28 offen sc0 sc1
    s_add_u32 s28, s33, 98304
    buffer_load_dwordx4 v[144:147], v6, s[12:15], s28 offen sc0 sc1
    s_add_u32 s28, s33, 9216
    buffer_load_dwordx4 v[148:151], v6, s[12:15], s28 offen sc0 sc1
    s_add_u32 s28, s33, 99328
    buffer_load_dwordx4 v[152:155], v6, s[12:15], s28 offen sc0 sc1
    s_add_u32 s28, s33, 10240
    buffer_load_dwordx4 v[156:159], v6, s[12:15], s28 offen sc0 sc1
    s_add_u32 s28, s33, 100352
    buffer_load_dwordx4 v[160:163], v6, s[12:15], s28 offen sc0 sc1
    s_add_u32 s28, s33, 11264
    buffer_load_dwordx4 v[164:167], v6, s[12:15], s28 offen sc0 sc1
    s_add_u32 s28, s33, 101376
    buffer_load_dwordx4 v[168:171], v6, s[12:15], s28 offen sc0 sc1
    s_add_u32 s28, s33, 12288
    buffer_load_dwordx4 v[172:175], v6, s[12:15], s28 offen sc0 sc1
    s_add_u32 s28, s33, 102400
    buffer_load_dwordx4 v[176:179], v6, s[12:15], s28 offen sc0 sc1
    s_add_u32 s28, s33, 13312
    buffer_load_dwordx4 v[180:183], v6, s[12:15], s28 offen sc0 sc1
    s_add_u32 s28, s33, 103424
    buffer_load_dwordx4 v[184:187], v6, s[12:15], s28 offen sc0 sc1
    s_waitcnt vmcnt(0)
    v_max3_u32 v3, v100, v101, v102
    v_max3_u32 v3, v3, v103, v104
    v_max3_u32 v3, v3, v105, v106
    v_max_u32 v3, v3, v107
    v_cmp_eq_u32 vcc, -1, v3
    s_sub_u32 s36, s36, 1
    s_cbranch_vccz L_p23_kernel_ga3_ok
    s_cmp_eq_u32 s36, 0
    s_cbranch_scc0 L_p23_kernel_ga3_rt
    s_branch L_p23_kernel_ga3_ok
L_p23_kernel_ga4_fix:
    s_mov_b32 s36, 1048576
L_p23_kernel_ga4_rt:
    s_add_u32 s28, s33, 4096
    buffer_load_dwordx4 v[108:111], v6, s[12:15], s28 offen sc0 sc1
    s_add_u32 s28, s33, 94208
    buffer_load_dwordx4 v[112:115], v6, s[12:15], s28 offen sc0 sc1
    s_add_u32 s28, s33, 5120
    buffer_load_dwordx4 v[116:119], v6, s[12:15], s28 offen sc0 sc1
    s_add_u32 s28, s33, 95232
    buffer_load_dwordx4 v[120:123], v6, s[12:15], s28 offen sc0 sc1
    s_add_u32 s28, s33, 6144
    buffer_load_dwordx4 v[124:127], v6, s[12:15], s28 offen sc0 sc1
    s_add_u32 s28, s33, 96256
    buffer_load_dwordx4 v[128:131], v6, s[12:15], s28 offen sc0 sc1
    s_add_u32 s28, s33, 7168
    buffer_load_dwordx4 v[132:135], v6, s[12:15], s28 offen sc0 sc1
    s_add_u32 s28, s33, 97280
    buffer_load_dwordx4 v[136:139], v6, s[12:15], s28 offen sc0 sc1
    s_add_u32 s28, s33, 8192
    buffer_load_dwordx4 v[140:143], v6, s[12:15], s28 offen sc0 sc1
    s_add_u32 s28, s33, 98304
    buffer_load_dwordx4 v[144:147], v6, s[12:15], s28 offen sc0 sc1
    s_add_u32 s28, s33, 9216
    buffer_load_dwordx4 v[148:151], v6, s[12:15], s28 offen sc0 sc1
    s_add_u32 s28, s33, 99328
    buffer_load_dwordx4 v[152:155], v6, s[12:15], s28 offen sc0 sc1
    s_add_u32 s28, s33, 10240
    buffer_load_dwordx4 v[156:159], v6, s[12:15], s28 offen sc0 sc1
    s_add_u32 s28, s33, 100352
    buffer_load_dwordx4 v[160:163], v6, s[12:15], s28 offen sc0 sc1
    s_add_u32 s28, s33, 11264
    buffer_load_dwordx4 v[164:167], v6, s[12:15], s28 offen sc0 sc1
    s_add_u32 s28, s33, 101376
    buffer_load_dwordx4 v[168:171], v6, s[12:15], s28 offen sc0 sc1
    s_add_u32 s28, s33, 12288
    buffer_load_dwordx4 v[172:175], v6, s[12:15], s28 offen sc0 sc1
    s_add_u32 s28, s33, 102400
    buffer_load_dwordx4 v[176:179], v6, s[12:15], s28 offen sc0 sc1
    s_add_u32 s28, s33, 13312
    buffer_load_dwordx4 v[180:183], v6, s[12:15], s28 offen sc0 sc1
    s_add_u32 s28, s33, 103424
    buffer_load_dwordx4 v[184:187], v6, s[12:15], s28 offen sc0 sc1
    s_waitcnt vmcnt(0)
    v_max3_u32 v3, v108, v109, v110
    v_max3_u32 v3, v3, v111, v112
    v_max3_u32 v3, v3, v113, v114
    v_max_u32 v3, v3, v115
    v_cmp_eq_u32 vcc, -1, v3
    s_sub_u32 s36, s36, 1
    s_cbranch_vccz L_p23_kernel_ga4_ok
    s_cmp_eq_u32 s36, 0
    s_cbranch_scc0 L_p23_kernel_ga4_rt
    s_branch L_p23_kernel_ga4_ok
L_p23_kernel_ga5_fix:
    s_mov_b32 s36, 1048576
L_p23_kernel_ga5_rt:
    s_add_u32 s28, s33, 5120
    buffer_load_dwordx4 v[116:119], v6, s[12:15], s28 offen sc0 sc1
    s_add_u32 s28, s33, 95232
    buffer_load_dwordx4 v[120:123], v6, s[12:15], s28 offen sc0 sc1
    s_add_u32 s28, s33, 6144
    buffer_load_dwordx4 v[124:127], v6, s[12:15], s28 offen sc0 sc1
    s_add_u32 s28, s33, 96256
    buffer_load_dwordx4 v[128:131], v6, s[12:15], s28 offen sc0 sc1
    s_add_u32 s28, s33, 7168
    buffer_load_dwordx4 v[132:135], v6, s[12:15], s28 offen sc0 sc1
    s_add_u32 s28, s33, 97280
    buffer_load_dwordx4 v[136:139], v6, s[12:15], s28 offen sc0 sc1
    s_add_u32 s28, s33, 8192
    buffer_load_dwordx4 v[140:143], v6, s[12:15], s28 offen sc0 sc1
    s_add_u32 s28, s33, 98304
    buffer_load_dwordx4 v[144:147], v6, s[12:15], s28 offen sc0 sc1
    s_add_u32 s28, s33, 9216
    buffer_load_dwordx4 v[148:151], v6, s[12:15], s28 offen sc0 sc1
    s_add_u32 s28, s33, 99328
    buffer_load_dwordx4 v[152:155], v6, s[12:15], s28 offen sc0 sc1
    s_add_u32 s28, s33, 10240
    buffer_load_dwordx4 v[156:159], v6, s[12:15], s28 offen sc0 sc1
    s_add_u32 s28, s33, 100352
    buffer_load_dwordx4 v[160:163], v6, s[12:15], s28 offen sc0 sc1
    s_add_u32 s28, s33, 11264
    buffer_load_dwordx4 v[164:167], v6, s[12:15], s28 offen sc0 sc1
    s_add_u32 s28, s33, 101376
    buffer_load_dwordx4 v[168:171], v6, s[12:15], s28 offen sc0 sc1
    s_add_u32 s28, s33, 12288
    buffer_load_dwordx4 v[172:175], v6, s[12:15], s28 offen sc0 sc1
    s_add_u32 s28, s33, 102400
    buffer_load_dwordx4 v[176:179], v6, s[12:15], s28 offen sc0 sc1
    s_add_u32 s28, s33, 13312
    buffer_load_dwordx4 v[180:183], v6, s[12:15], s28 offen sc0 sc1
    s_add_u32 s28, s33, 103424
    buffer_load_dwordx4 v[184:187], v6, s[12:15], s28 offen sc0 sc1
    s_waitcnt vmcnt(0)
    v_max3_u32 v3, v116, v117, v118
    v_max3_u32 v3, v3, v119, v120
    v_max3_u32 v3, v3, v121, v122
    v_max_u32 v3, v3, v123
    v_cmp_eq_u32 vcc, -1, v3
    s_sub_u32 s36, s36, 1
    s_cbranch_vccz L_p23_kernel_ga5_ok
    s_cmp_eq_u32 s36, 0
    s_cbranch_scc0 L_p23_kernel_ga5_rt
    s_branch L_p23_kernel_ga5_ok
L_p23_kernel_ga6_fix:
    s_mov_b32 s36, 1048576
L_p23_kernel_ga6_rt:
    s_add_u32 s28, s33, 6144
    buffer_load_dwordx4 v[124:127], v6, s[12:15], s28 offen sc0 sc1
    s_add_u32 s28, s33, 96256
    buffer_load_dwordx4 v[128:131], v6, s[12:15], s28 offen sc0 sc1
    s_add_u32 s28, s33, 7168
    buffer_load_dwordx4 v[132:135], v6, s[12:15], s28 offen sc0 sc1
    s_add_u32 s28, s33, 97280
    buffer_load_dwordx4 v[136:139], v6, s[12:15], s28 offen sc0 sc1
    s_add_u32 s28, s33, 8192
    buffer_load_dwordx4 v[140:143], v6, s[12:15], s28 offen sc0 sc1
    s_add_u32 s28, s33, 98304
    buffer_load_dwordx4 v[144:147], v6, s[12:15], s28 offen sc0 sc1
    s_add_u32 s28, s33, 9216
    buffer_load_dwordx4 v[148:151], v6, s[12:15], s28 offen sc0 sc1
    s_add_u32 s28, s33, 99328
    buffer_load_dwordx4 v[152:155], v6, s[12:15], s28 offen sc0 sc1
    s_add_u32 s28, s33, 10240
    buffer_load_dwordx4 v[156:159], v6, s[12:15], s28 offen sc0 sc1
    s_add_u32 s28, s33, 100352
    buffer_load_dwordx4 v[160:163], v6, s[12:15], s28 offen sc0 sc1
    s_add_u32 s28, s33, 11264
    buffer_load_dwordx4 v[164:167], v6, s[12:15], s28 offen sc0 sc1
    s_add_u32 s28, s33, 101376
    buffer_load_dwordx4 v[168:171], v6, s[12:15], s28 offen sc0 sc1
    s_add_u32 s28, s33, 12288
    buffer_load_dwordx4 v[172:175], v6, s[12:15], s28 offen sc0 sc1
    s_add_u32 s28, s33, 102400
    buffer_load_dwordx4 v[176:179], v6, s[12:15], s28 offen sc0 sc1
    s_add_u32 s28, s33, 13312
    buffer_load_dwordx4 v[180:183], v6, s[12:15], s28 offen sc0 sc1
    s_add_u32 s28, s33, 103424
    buffer_load_dwordx4 v[184:187], v6, s[12:15], s28 offen sc0 sc1
    s_waitcnt vmcnt(0)
    v_max3_u32 v3, v124, v125, v126
    v_max3_u32 v3, v3, v127, v128
    v_max3_u32 v3, v3, v129, v130
    v_max_u32 v3, v3, v131
    v_cmp_eq_u32 vcc, -1, v3
    s_sub_u32 s36, s36, 1
    s_cbranch_vccz L_p23_kernel_ga6_ok
    s_cmp_eq_u32 s36, 0
    s_cbranch_scc0 L_p23_kernel_ga6_rt
    s_branch L_p23_kernel_ga6_ok
L_p23_kernel_ga7_fix:
    s_mov_b32 s36, 1048576
L_p23_kernel_ga7_rt:
    s_add_u32 s28, s33, 7168
    buffer_load_dwordx4 v[132:135], v6, s[12:15], s28 offen sc0 sc1
    s_add_u32 s28, s33, 97280
    buffer_load_dwordx4 v[136:139], v6, s[12:15], s28 offen sc0 sc1
    s_add_u32 s28, s33, 8192
    buffer_load_dwordx4 v[140:143], v6, s[12:15], s28 offen sc0 sc1
    s_add_u32 s28, s33, 98304
    buffer_load_dwordx4 v[144:147], v6, s[12:15], s28 offen sc0 sc1
    s_add_u32 s28, s33, 9216
    buffer_load_dwordx4 v[148:151], v6, s[12:15], s28 offen sc0 sc1
    s_add_u32 s28, s33, 99328
    buffer_load_dwordx4 v[152:155], v6, s[12:15], s28 offen sc0 sc1
    s_add_u32 s28, s33, 10240
    buffer_load_dwordx4 v[156:159], v6, s[12:15], s28 offen sc0 sc1
    s_add_u32 s28, s33, 100352
    buffer_load_dwordx4 v[160:163], v6, s[12:15], s28 offen sc0 sc1
    s_add_u32 s28, s33, 11264
    buffer_load_dwordx4 v[164:167], v6, s[12:15], s28 offen sc0 sc1
    s_add_u32 s28, s33, 101376
    buffer_load_dwordx4 v[168:171], v6, s[12:15], s28 offen sc0 sc1
    s_add_u32 s28, s33, 12288
    buffer_load_dwordx4 v[172:175], v6, s[12:15], s28 offen sc0 sc1
    s_add_u32 s28, s33, 102400
    buffer_load_dwordx4 v[176:179], v6, s[12:15], s28 offen sc0 sc1
    s_add_u32 s28, s33, 13312
    buffer_load_dwordx4 v[180:183], v6, s[12:15], s28 offen sc0 sc1
    s_add_u32 s28, s33, 103424
    buffer_load_dwordx4 v[184:187], v6, s[12:15], s28 offen sc0 sc1
    s_waitcnt vmcnt(0)
    v_max3_u32 v3, v132, v133, v134
    v_max3_u32 v3, v3, v135, v136
    v_max3_u32 v3, v3, v137, v138
    v_max_u32 v3, v3, v139
    v_cmp_eq_u32 vcc, -1, v3
    s_sub_u32 s36, s36, 1
    s_cbranch_vccz L_p23_kernel_ga7_ok
    s_cmp_eq_u32 s36, 0
    s_cbranch_scc0 L_p23_kernel_ga7_rt
    s_branch L_p23_kernel_ga7_ok
L_p23_kernel_ga8_fix:
    s_mov_b32 s36, 1048576
L_p23_kernel_ga8_rt:
    s_add_u32 s28, s33, 8192
    buffer_load_dwordx4 v[140:143], v6, s[12:15], s28 offen sc0 sc1
    s_add_u32 s28, s33, 98304
    buffer_load_dwordx4 v[144:147], v6, s[12:15], s28 offen sc0 sc1
    s_add_u32 s28, s33, 9216
    buffer_load_dwordx4 v[148:151], v6, s[12:15], s28 offen sc0 sc1
    s_add_u32 s28, s33, 99328
    buffer_load_dwordx4 v[152:155], v6, s[12:15], s28 offen sc0 sc1
    s_add_u32 s28, s33, 10240
    buffer_load_dwordx4 v[156:159], v6, s[12:15], s28 offen sc0 sc1
    s_add_u32 s28, s33, 100352
    buffer_load_dwordx4 v[160:163], v6, s[12:15], s28 offen sc0 sc1
    s_add_u32 s28, s33, 11264
    buffer_load_dwordx4 v[164:167], v6, s[12:15], s28 offen sc0 sc1
    s_add_u32 s28, s33, 101376
    buffer_load_dwordx4 v[168:171], v6, s[12:15], s28 offen sc0 sc1
    s_add_u32 s28, s33, 12288
    buffer_load_dwordx4 v[172:175], v6, s[12:15], s28 offen sc0 sc1
    s_add_u32 s28, s33, 102400
    buffer_load_dwordx4 v[176:179], v6, s[12:15], s28 offen sc0 sc1
    s_add_u32 s28, s33, 13312
    buffer_load_dwordx4 v[180:183], v6, s[12:15], s28 offen sc0 sc1
    s_add_u32 s28, s33, 103424
    buffer_load_dwordx4 v[184:187], v6, s[12:15], s28 offen sc0 sc1
    s_waitcnt vmcnt(0)
    v_max3_u32 v3, v140, v141, v142
    v_max3_u32 v3, v3, v143, v144
    v_max3_u32 v3, v3, v145, v146
    v_max_u32 v3, v3, v147
    v_cmp_eq_u32 vcc, -1, v3
    s_sub_u32 s36, s36, 1
    s_cbranch_vccz L_p23_kernel_ga8_ok
    s_cmp_eq_u32 s36, 0
    s_cbranch_scc0 L_p23_kernel_ga8_rt
    s_branch L_p23_kernel_ga8_ok
L_p23_kernel_ga9_fix:
    s_mov_b32 s36, 1048576
L_p23_kernel_ga9_rt:
    s_add_u32 s28, s33, 9216
    buffer_load_dwordx4 v[148:151], v6, s[12:15], s28 offen sc0 sc1
    s_add_u32 s28, s33, 99328
    buffer_load_dwordx4 v[152:155], v6, s[12:15], s28 offen sc0 sc1
    s_add_u32 s28, s33, 10240
    buffer_load_dwordx4 v[156:159], v6, s[12:15], s28 offen sc0 sc1
    s_add_u32 s28, s33, 100352
    buffer_load_dwordx4 v[160:163], v6, s[12:15], s28 offen sc0 sc1
    s_add_u32 s28, s33, 11264
    buffer_load_dwordx4 v[164:167], v6, s[12:15], s28 offen sc0 sc1
    s_add_u32 s28, s33, 101376
    buffer_load_dwordx4 v[168:171], v6, s[12:15], s28 offen sc0 sc1
    s_add_u32 s28, s33, 12288
    buffer_load_dwordx4 v[172:175], v6, s[12:15], s28 offen sc0 sc1
    s_add_u32 s28, s33, 102400
    buffer_load_dwordx4 v[176:179], v6, s[12:15], s28 offen sc0 sc1
    s_add_u32 s28, s33, 13312
    buffer_load_dwordx4 v[180:183], v6, s[12:15], s28 offen sc0 sc1
    s_add_u32 s28, s33, 103424
    buffer_load_dwordx4 v[184:187], v6, s[12:15], s28 offen sc0 sc1
    s_waitcnt vmcnt(0)
    v_max3_u32 v3, v148, v149, v150
    v_max3_u32 v3, v3, v151, v152
    v_max3_u32 v3, v3, v153, v154
    v_max_u32 v3, v3, v155
    v_cmp_eq_u32 vcc, -1, v3
    s_sub_u32 s36, s36, 1
    s_cbranch_vccz L_p23_kernel_ga9_ok
    s_cmp_eq_u32 s36, 0
    s_cbranch_scc0 L_p23_kernel_ga9_rt
    s_branch L_p23_kernel_ga9_ok
L_p23_kernel_ga10_fix:
    s_mov_b32 s36, 1048576
L_p23_kernel_ga10_rt:
    s_add_u32 s28, s33, 10240
    buffer_load_dwordx4 v[156:159], v6, s[12:15], s28 offen sc0 sc1
    s_add_u32 s28, s33, 100352
    buffer_load_dwordx4 v[160:163], v6, s[12:15], s28 offen sc0 sc1
    s_add_u32 s28, s33, 11264
    buffer_load_dwordx4 v[164:167], v6, s[12:15], s28 offen sc0 sc1
    s_add_u32 s28, s33, 101376
    buffer_load_dwordx4 v[168:171], v6, s[12:15], s28 offen sc0 sc1
    s_add_u32 s28, s33, 12288
    buffer_load_dwordx4 v[172:175], v6, s[12:15], s28 offen sc0 sc1
    s_add_u32 s28, s33, 102400
    buffer_load_dwordx4 v[176:179], v6, s[12:15], s28 offen sc0 sc1
    s_add_u32 s28, s33, 13312
    buffer_load_dwordx4 v[180:183], v6, s[12:15], s28 offen sc0 sc1
    s_add_u32 s28, s33, 103424
    buffer_load_dwordx4 v[184:187], v6, s[12:15], s28 offen sc0 sc1
    s_waitcnt vmcnt(0)
    v_max3_u32 v3, v156, v157, v158
    v_max3_u32 v3, v3, v159, v160
    v_max3_u32 v3, v3, v161, v162
    v_max_u32 v3, v3, v163
    v_cmp_eq_u32 vcc, -1, v3
    s_sub_u32 s36, s36, 1
    s_cbranch_vccz L_p23_kernel_ga10_ok
    s_cmp_eq_u32 s36, 0
    s_cbranch_scc0 L_p23_kernel_ga10_rt
    s_branch L_p23_kernel_ga10_ok
L_p23_kernel_ga11_fix:
    s_mov_b32 s36, 1048576
L_p23_kernel_ga11_rt:
    s_add_u32 s28, s33, 11264
    buffer_load_dwordx4 v[164:167], v6, s[12:15], s28 offen sc0 sc1
    s_add_u32 s28, s33, 101376
    buffer_load_dwordx4 v[168:171], v6, s[12:15], s28 offen sc0 sc1
    s_add_u32 s28, s33, 12288
    buffer_load_dwordx4 v[172:175], v6, s[12:15], s28 offen sc0 sc1
    s_add_u32 s28, s33, 102400
    buffer_load_dwordx4 v[176:179], v6, s[12:15], s28 offen sc0 sc1
    s_add_u32 s28, s33, 13312
    buffer_load_dwordx4 v[180:183], v6, s[12:15], s28 offen sc0 sc1
    s_add_u32 s28, s33, 103424
    buffer_load_dwordx4 v[184:187], v6, s[12:15], s28 offen sc0 sc1
    s_waitcnt vmcnt(0)
    v_max3_u32 v3, v164, v165, v166
    v_max3_u32 v3, v3, v167, v168
    v_max3_u32 v3, v3, v169, v170
    v_max_u32 v3, v3, v171
    v_cmp_eq_u32 vcc, -1, v3
    s_sub_u32 s36, s36, 1
    s_cbranch_vccz L_p23_kernel_ga11_ok
    s_cmp_eq_u32 s36, 0
    s_cbranch_scc0 L_p23_kernel_ga11_rt
    s_branch L_p23_kernel_ga11_ok
L_p23_kernel_ga12_fix:
    s_mov_b32 s36, 1048576
L_p23_kernel_ga12_rt:
    s_add_u32 s28, s33, 12288
    buffer_load_dwordx4 v[172:175], v6, s[12:15], s28 offen sc0 sc1
    s_add_u32 s28, s33, 102400
    buffer_load_dwordx4 v[176:179], v6, s[12:15], s28 offen sc0 sc1
    s_add_u32 s28, s33, 13312
    buffer_load_dwordx4 v[180:183], v6, s[12:15], s28 offen sc0 sc1
    s_add_u32 s28, s33, 103424
    buffer_load_dwordx4 v[184:187], v6, s[12:15], s28 offen sc0 sc1
    s_waitcnt vmcnt(0)
    v_max3_u32 v3, v172, v173, v174
    v_max3_u32 v3, v3, v175, v176
    v_max3_u32 v3, v3, v177, v178
    v_max_u32 v3, v3, v179
    v_cmp_eq_u32 vcc, -1, v3
    s_sub_u32 s36, s36, 1
    s_cbranch_vccz L_p23_kernel_ga12_ok
    s_cmp_eq_u32 s36, 0
    s_cbranch_scc0 L_p23_kernel_ga12_rt
    s_branch L_p23_kernel_ga12_ok
L_p23_kernel_ga13_fix:
    s_mov_b32 s36, 1048576
L_p23_kernel_ga13_rt:
    s_add_u32 s28, s33, 13312
    buffer_load_dwordx4 v[180:183], v6, s[12:15], s28 offen sc0 sc1
    s_add_u32 s28, s33, 103424
    buffer_load_dwordx4 v[184:187], v6, s[12:15], s28 offen sc0 sc1
    s_waitcnt vmcnt(0)
    v_max3_u32 v3, v180, v181, v182
    v_max3_u32 v3, v3, v183, v184
    v_max3_u32 v3, v3, v185, v186
    v_max_u32 v3, v3, v187
    v_cmp_eq_u32 vcc, -1, v3
    s_sub_u32 s36, s36, 1
    s_cbranch_vccz L_p23_kernel_ga13_ok
    s_cmp_eq_u32 s36, 0
    s_cbranch_scc0 L_p23_kernel_ga13_rt
    s_branch L_p23_kernel_ga13_ok
L_p23_kernel_go0_fix:
    s_mov_b32 s36, 1048576
L_p23_kernel_go0_rt:
    s_add_u32 s28, s33, 0
    buffer_load_dwordx4 v[76:79], v6, s[12:15], s28 offen sc0 sc1
    s_add_u32 s28, s33, 90112
    buffer_load_dwordx4 v[80:83], v6, s[12:15], s28 offen sc0 sc1
    s_add_u32 s28, s33, 1024
    buffer_load_dwordx4 v[84:87], v6, s[12:15], s28 offen sc0 sc1
    s_add_u32 s28, s33, 91136
    buffer_load_dwordx4 v[88:91], v6, s[12:15], s28 offen sc0 sc1
    s_add_u32 s28, s33, 2048
    buffer_load_dwordx4 v[92:95], v6, s[12:15], s28 offen sc0 sc1
    s_add_u32 s28, s33, 92160
    buffer_load_dwordx4 v[96:99], v6, s[12:15], s28 offen sc0 sc1
    s_add_u32 s28, s33, 3072
    buffer_load_dwordx4 v[100:103], v6, s[12:15], s28 offen sc0 sc1
    s_add_u32 s28, s33, 93184
    buffer_load_dwordx4 v[104:107], v6, s[12:15], s28 offen sc0 sc1
    s_add_u32 s28, s33, 4096
    buffer_load_dwordx4 v[108:111], v6, s[12:15], s28 offen sc0 sc1
    s_add_u32 s28, s33, 94208
    buffer_load_dwordx4 v[112:115], v6, s[12:15], s28 offen sc0 sc1
    s_add_u32 s28, s33, 5120
    buffer_load_dwordx4 v[116:119], v6, s[12:15], s28 offen sc0 sc1
    s_add_u32 s28, s33, 95232
    buffer_load_dwordx4 v[120:123], v6, s[12:15], s28 offen sc0 sc1
    s_add_u32 s28, s33, 6144
    buffer_load_dwordx4 v[124:127], v6, s[12:15], s28 offen sc0 sc1
    s_add_u32 s28, s33, 96256
    buffer_load_dwordx4 v[128:131], v6, s[12:15], s28 offen sc0 sc1
    s_add_u32 s28, s33, 7168
    buffer_load_dwordx4 v[132:135], v6, s[12:15], s28 offen sc0 sc1
    s_add_u32 s28, s33, 97280
    buffer_load_dwordx4 v[136:139], v6, s[12:15], s28 offen sc0 sc1
    s_waitcnt vmcnt(0)
    v_max3_u32 v3, v76, v77, v78
    v_max3_u32 v3, v3, v79, v80
    v_max3_u32 v3, v3, v81, v82
    v_max_u32 v3, v3, v83
    v_cmp_eq_u32 vcc, -1, v3
    s_sub_u32 s36, s36, 1
    s_cbranch_vccz L_p23_kernel_go0_ok
    s_cmp_eq_u32 s36, 0
    s_cbranch_scc0 L_p23_kernel_go0_rt
    s_branch L_p23_kernel_go0_ok
L_p23_kernel_go1_fix:
    s_mov_b32 s36, 1048576
L_p23_kernel_go1_rt:
    s_add_u32 s28, s33, 1024
    buffer_load_dwordx4 v[84:87], v6, s[12:15], s28 offen sc0 sc1
    s_add_u32 s28, s33, 91136
    buffer_load_dwordx4 v[88:91], v6, s[12:15], s28 offen sc0 sc1
    s_add_u32 s28, s33, 2048
    buffer_load_dwordx4 v[92:95], v6, s[12:15], s28 offen sc0 sc1
    s_add_u32 s28, s33, 92160
    buffer_load_dwordx4 v[96:99], v6, s[12:15], s28 offen sc0 sc1
    s_add_u32 s28, s33, 3072
    buffer_load_dwordx4 v[100:103], v6, s[12:15], s28 offen sc0 sc1
    s_add_u32 s28, s33, 93184
    buffer_load_dwordx4 v[104:107], v6, s[12:15], s28 offen sc0 sc1
    s_add_u32 s28, s33, 4096
    buffer_load_dwordx4 v[108:111], v6, s[12:15], s28 offen sc0 sc1
    s_add_u32 s28, s33, 94208
    buffer_load_dwordx4 v[112:115], v6, s[12:15], s28 offen sc0 sc1
    s_add_u32 s28, s33, 5120
    buffer_load_dwordx4 v[116:119], v6, s[12:15], s28 offen sc0 sc1
    s_add_u32 s28, s33, 95232
    buffer_load_dwordx4 v[120:123], v6, s[12:15], s28 offen sc0 sc1
    s_add_u32 s28, s33, 6144
    buffer_load_dwordx4 v[124:127], v6, s[12:15], s28 offen sc0 sc1
    s_add_u32 s28, s33, 96256
    buffer_load_dwordx4 v[128:131], v6, s[12:15], s28 offen sc0 sc1
    s_add_u32 s28, s33, 7168
    buffer_load_dwordx4 v[132:135], v6, s[12:15], s28 offen sc0 sc1
    s_add_u32 s28, s33, 97280
    buffer_load_dwordx4 v[136:139], v6, s[12:15], s28 offen sc0 sc1
    s_waitcnt vmcnt(0)
    v_max3_u32 v3, v84, v85, v86
    v_max3_u32 v3, v3, v87, v88
    v_max3_u32 v3, v3, v89, v90
    v_max_u32 v3, v3, v91
    v_cmp_eq_u32 vcc, -1, v3
    s_sub_u32 s36, s36, 1
    s_cbranch_vccz L_p23_kernel_go1_ok
    s_cmp_eq_u32 s36, 0
    s_cbranch_scc0 L_p23_kernel_go1_rt
    s_branch L_p23_kernel_go1_ok
L_p23_kernel_go2_fix:
    s_mov_b32 s36, 1048576
L_p23_kernel_go2_rt:
    s_add_u32 s28, s33, 2048
    buffer_load_dwordx4 v[92:95], v6, s[12:15], s28 offen sc0 sc1
    s_add_u32 s28, s33, 92160
    buffer_load_dwordx4 v[96:99], v6, s[12:15], s28 offen sc0 sc1
    s_add_u32 s28, s33, 3072
    buffer_load_dwordx4 v[100:103], v6, s[12:15], s28 offen sc0 sc1
    s_add_u32 s28, s33, 93184
    buffer_load_dwordx4 v[104:107], v6, s[12:15], s28 offen sc0 sc1
    s_add_u32 s28, s33, 4096
    buffer_load_dwordx4 v[108:111], v6, s[12:15], s28 offen sc0 sc1
    s_add_u32 s28, s33, 94208
    buffer_load_dwordx4 v[112:115], v6, s[12:15], s28 offen sc0 sc1
    s_add_u32 s28, s33, 5120
    buffer_load_dwordx4 v[116:119], v6, s[12:15], s28 offen sc0 sc1
    s_add_u32 s28, s33, 95232
    buffer_load_dwordx4 v[120:123], v6, s[12:15], s28 offen sc0 sc1
    s_add_u32 s28, s33, 6144
    buffer_load_dwordx4 v[124:127], v6, s[12:15], s28 offen sc0 sc1
    s_add_u32 s28, s33, 96256
    buffer_load_dwordx4 v[128:131], v6, s[12:15], s28 offen sc0 sc1
    s_add_u32 s28, s33, 7168
    buffer_load_dwordx4 v[132:135], v6, s[12:15], s28 offen sc0 sc1
    s_add_u32 s28, s33, 97280
    buffer_load_dwordx4 v[136:139], v6, s[12:15], s28 offen sc0 sc1
    s_waitcnt vmcnt(0)
    v_max3_u32 v3, v92, v93, v94
    v_max3_u32 v3, v3, v95, v96
    v_max3_u32 v3, v3, v97, v98
    v_max_u32 v3, v3, v99
    v_cmp_eq_u32 vcc, -1, v3
    s_sub_u32 s36, s36, 1
    s_cbranch_vccz L_p23_kernel_go2_ok
    s_cmp_eq_u32 s36, 0
    s_cbranch_scc0 L_p23_kernel_go2_rt
    s_branch L_p23_kernel_go2_ok
L_p23_kernel_go3_fix:
    s_mov_b32 s36, 1048576
L_p23_kernel_go3_rt:
    s_add_u32 s28, s33, 3072
    buffer_load_dwordx4 v[100:103], v6, s[12:15], s28 offen sc0 sc1
    s_add_u32 s28, s33, 93184
    buffer_load_dwordx4 v[104:107], v6, s[12:15], s28 offen sc0 sc1
    s_add_u32 s28, s33, 4096
    buffer_load_dwordx4 v[108:111], v6, s[12:15], s28 offen sc0 sc1
    s_add_u32 s28, s33, 94208
    buffer_load_dwordx4 v[112:115], v6, s[12:15], s28 offen sc0 sc1
    s_add_u32 s28, s33, 5120
    buffer_load_dwordx4 v[116:119], v6, s[12:15], s28 offen sc0 sc1
    s_add_u32 s28, s33, 95232
    buffer_load_dwordx4 v[120:123], v6, s[12:15], s28 offen sc0 sc1
    s_add_u32 s28, s33, 6144
    buffer_load_dwordx4 v[124:127], v6, s[12:15], s28 offen sc0 sc1
    s_add_u32 s28, s33, 96256
    buffer_load_dwordx4 v[128:131], v6, s[12:15], s28 offen sc0 sc1
    s_add_u32 s28, s33, 7168
    buffer_load_dwordx4 v[132:135], v6, s[12:15], s28 offen sc0 sc1
    s_add_u32 s28, s33, 97280
    buffer_load_dwordx4 v[136:139], v6, s[12:15], s28 offen sc0 sc1
    s_waitcnt vmcnt(0)
    v_max3_u32 v3, v100, v101, v102
    v_max3_u32 v3, v3, v103, v104
    v_max3_u32 v3, v3, v105, v106
    v_max_u32 v3, v3, v107
    v_cmp_eq_u32 vcc, -1, v3
    s_sub_u32 s36, s36, 1
    s_cbranch_vccz L_p23_kernel_go3_ok
    s_cmp_eq_u32 s36, 0
    s_cbranch_scc0 L_p23_kernel_go3_rt
    s_branch L_p23_kernel_go3_ok
L_p23_kernel_go4_fix:
    s_mov_b32 s36, 1048576
L_p23_kernel_go4_rt:
    s_add_u32 s28, s33, 4096
    buffer_load_dwordx4 v[108:111], v6, s[12:15], s28 offen sc0 sc1
    s_add_u32 s28, s33, 94208
    buffer_load_dwordx4 v[112:115], v6, s[12:15], s28 offen sc0 sc1
    s_add_u32 s28, s33, 5120
    buffer_load_dwordx4 v[116:119], v6, s[12:15], s28 offen sc0 sc1
    s_add_u32 s28, s33, 95232
    buffer_load_dwordx4 v[120:123], v6, s[12:15], s28 offen sc0 sc1
    s_add_u32 s28, s33, 6144
    buffer_load_dwordx4 v[124:127], v6, s[12:15], s28 offen sc0 sc1
    s_add_u32 s28, s33, 96256
    buffer_load_dwordx4 v[128:131], v6, s[12:15], s28 offen sc0 sc1
    s_add_u32 s28, s33, 7168
    buffer_load_dwordx4 v[132:135], v6, s[12:15], s28 offen sc0 sc1
    s_add_u32 s28, s33, 97280
    buffer_load_dwordx4 v[136:139], v6, s[12:15], s28 offen sc0 sc1
    s_waitcnt vmcnt(0)
    v_max3_u32 v3, v108, v109, v110
    v_max3_u32 v3, v3, v111, v112
    v_max3_u32 v3, v3, v113, v114
    v_max_u32 v3, v3, v115
    v_cmp_eq_u32 vcc, -1, v3
    s_sub_u32 s36, s36, 1
    s_cbranch_vccz L_p23_kernel_go4_ok
    s_cmp_eq_u32 s36, 0
    s_cbranch_scc0 L_p23_kernel_go4_rt
    s_branch L_p23_kernel_go4_ok
L_p23_kernel_go5_fix:
    s_mov_b32 s36, 1048576
L_p23_kernel_go5_rt:
    s_add_u32 s28, s33, 5120
    buffer_load_dwordx4 v[116:119], v6, s[12:15], s28 offen sc0 sc1
    s_add_u32 s28, s33, 95232
    buffer_load_dwordx4 v[120:123], v6, s[12:15], s28 offen sc0 sc1
    s_add_u32 s28, s33, 6144
    buffer_load_dwordx4 v[124:127], v6, s[12:15], s28 offen sc0 sc1
    s_add_u32 s28, s33, 96256
    buffer_load_dwordx4 v[128:131], v6, s[12:15], s28 offen sc0 sc1
    s_add_u32 s28, s33, 7168
    buffer_load_dwordx4 v[132:135], v6, s[12:15], s28 offen sc0 sc1
    s_add_u32 s28, s33, 97280
    buffer_load_dwordx4 v[136:139], v6, s[12:15], s28 offen sc0 sc1
    s_waitcnt vmcnt(0)
    v_max3_u32 v3, v116, v117, v118
    v_max3_u32 v3, v3, v119, v120
    v_max3_u32 v3, v3, v121, v122
    v_max_u32 v3, v3, v123
    v_cmp_eq_u32 vcc, -1, v3
    s_sub_u32 s36, s36, 1
    s_cbranch_vccz L_p23_kernel_go5_ok
    s_cmp_eq_u32 s36, 0
    s_cbranch_scc0 L_p23_kernel_go5_rt
    s_branch L_p23_kernel_go5_ok
L_p23_kernel_go6_fix:
    s_mov_b32 s36, 1048576
L_p23_kernel_go6_rt:
    s_add_u32 s28, s33, 6144
    buffer_load_dwordx4 v[124:127], v6, s[12:15], s28 offen sc0 sc1
    s_add_u32 s28, s33, 96256
    buffer_load_dwordx4 v[128:131], v6, s[12:15], s28 offen sc0 sc1
    s_add_u32 s28, s33, 7168
    buffer_load_dwordx4 v[132:135], v6, s[12:15], s28 offen sc0 sc1
    s_add_u32 s28, s33, 97280
    buffer_load_dwordx4 v[136:139], v6, s[12:15], s28 offen sc0 sc1
    s_waitcnt vmcnt(0)
    v_max3_u32 v3, v124, v125, v126
    v_max3_u32 v3, v3, v127, v128
    v_max3_u32 v3, v3, v129, v130
    v_max_u32 v3, v3, v131
    v_cmp_eq_u32 vcc, -1, v3
    s_sub_u32 s36, s36, 1
    s_cbranch_vccz L_p23_kernel_go6_ok
    s_cmp_eq_u32 s36, 0
    s_cbranch_scc0 L_p23_kernel_go6_rt
    s_branch L_p23_kernel_go6_ok
L_p23_kernel_go7_fix:
    s_mov_b32 s36, 1048576
L_p23_kernel_go7_rt:
    s_add_u32 s28, s33, 7168
    buffer_load_dwordx4 v[132:135], v6, s[12:15], s28 offen sc0 sc1
    s_add_u32 s28, s33, 97280
    buffer_load_dwordx4 v[136:139], v6, s[12:15], s28 offen sc0 sc1
    s_waitcnt vmcnt(0)
    v_max3_u32 v3, v132, v133, v134
    v_max3_u32 v3, v3, v135, v136
    v_max3_u32 v3, v3, v137, v138
    v_max_u32 v3, v3, v139
    v_cmp_eq_u32 vcc, -1, v3
    s_sub_u32 s36, s36, 1
    s_cbranch_vccz L_p23_kernel_go7_ok
    s_cmp_eq_u32 s36, 0
    s_cbranch_scc0 L_p23_kernel_go7_rt
    s_branch L_p23_kernel_go7_ok
p23_kernel_codeend:
    s_endpgm

.section .rodata,"a"
.p2align 6
.amdhsa_kernel p23_kernel
  .amdhsa_next_free_vgpr 256
  .amdhsa_next_free_sgpr 100
  .amdhsa_accum_offset 256
  .amdhsa_group_segment_fixed_size 0
  .amdhsa_kernarg_size 104
  .amdhsa_user_sgpr_count 2
  .amdhsa_user_sgpr_kernarg_segment_ptr 1
  .amdhsa_system_sgpr_workgroup_id_x 1
  .amdhsa_float_denorm_mode_32 3
  .amdhsa_float_denorm_mode_16_64 3
.end_amdhsa_kernel
```
